```python
import torch

def _softmax(x, axis=-1):
    return torch.softmax(x, dim=axis)
def _gelu(x):
    return torch.nn.functional.gelu(x, approximate="tanh")
def _silu(x):
    return torch.nn.functional.silu(x)
def _sigmoid(x):
    return torch.sigmoid(x)
def _layernorm(x, axis=-1, eps=1e-5):
    m = x.mean(dim=axis, keepdim=True)
    v = x.var(dim=axis, keepdim=True, unbiased=False)
    return (x - m) / torch.sqrt(v + eps)
def _scatter_add(tgt, idx, src, axis=0):
    return tgt.clone().index_add_(axis, idx, src)
def _segment_sum(src, seg, n):
    out = torch.zeros((n,) + src.shape[1:], dtype=src.dtype)
    return out.index_add_(0, seg, src)
def _pad(x, pw):
    flat = tuple(v for pair in reversed(pw) for v in pair)
    return torch.nn.functional.pad(x, flat)

kernel_name = 'parallel_sum__ssm_conv_s5__geglu_ffn__prompt'

def setup_inputs():

    _w = (lambda a: (lambda t: t.to(torch.bfloat16) if t.is_floating_point() else t)(torch.as_tensor(a)))
    def _A_setup():
        B, S, D = 1, 2048, 512
        P = D
        Lambda_re = -0.5 * (lambda _x: torch.exp(torch.as_tensor(_x)))((lambda *s: torch.randn(*s, dtype=torch.bfloat16) * 0.8)(P))
        Lambda_im = (lambda *s: torch.randn(*s, dtype=torch.bfloat16) * 0.8)(P) * 1.0
        B_re = (lambda *s: torch.randn(*s, dtype=torch.bfloat16) * 0.8)(P, D) * (D ** -0.5)
        B_im = (lambda *s: torch.randn(*s, dtype=torch.bfloat16) * 0.8)(P, D) * (D ** -0.5)
        C_re = (lambda *s: torch.randn(*s, dtype=torch.bfloat16) * 0.8)(D, P) * (P ** -0.5)
        C_im = (lambda *s: torch.randn(*s, dtype=torch.bfloat16) * 0.8)(D, P) * (P ** -0.5)
        log_dt = (lambda *s: torch.randn(*s, dtype=torch.bfloat16) * 0.8)(P) * 0.3 - 2.0
        Dskip = (lambda *s: torch.randn(*s, dtype=torch.bfloat16) * 0.8)(D)
        return {
            "x": _w((lambda *s: torch.randn(*s, dtype=torch.bfloat16) * 0.05)(B, S, D)),
            "Lambda_re": _w(Lambda_re),
            "Lambda_im": _w(Lambda_im),
            "B_re": _w(B_re),
            "B_im": _w(B_im),
            "C_re": _w(C_re),
            "C_im": _w(C_im),
            "log_dt": _w(log_dt),
            "Dskip": _w(Dskip),
        }
    _A_in = _A_setup()

    def _B_setup():
        B, S, D, F = 1, 2048, 512, 1376
        return {
            "x": _w((lambda *s: torch.randn(*s, dtype=torch.bfloat16) * 0.05)(B, S, D)),
            "w_gate": _w((lambda *s: torch.randn(*s, dtype=torch.bfloat16) * 0.05)(D, F)),
            "w_up": _w((lambda *s: torch.randn(*s, dtype=torch.bfloat16) * 0.05)(D, F)),
            "w_down": _w((lambda *s: torch.randn(*s, dtype=torch.bfloat16) * 0.05)(F, D)),
        }
    _B_in = _B_setup()

    return {
        "A_x": _A_in["x"],
        "A_Lambda_re": _A_in["Lambda_re"],
        "A_Lambda_im": _A_in["Lambda_im"],
        "A_B_re": _A_in["B_re"],
        "A_B_im": _A_in["B_im"],
        "A_C_re": _A_in["C_re"],
        "A_C_im": _A_in["C_im"],
        "A_log_dt": _A_in["log_dt"],
        "A_Dskip": _A_in["Dskip"],
        "B_x": _B_in["x"],
        "B_w_gate": _B_in["w_gate"],
        "B_w_up": _B_in["w_up"],
        "B_w_down": _B_in["w_down"],
    }

def reference(A_x, A_Lambda_re, A_Lambda_im, A_B_re, A_B_im, A_C_re, A_C_im, A_log_dt, A_Dskip, B_x, B_w_gate, B_w_up, B_w_down):
    def _A_ref(x, Lambda_re, Lambda_im, B_re, B_im, C_re, C_im, log_dt, Dskip):
        Bsz, L, H = x.shape
        Lam = Lambda_re + 1j * Lambda_im
        Bmat = B_re + 1j * B_im
        Cmat = C_re + 1j * C_im
        dt = torch.exp(log_dt)
        Lam_bar = torch.exp(dt * Lam)
        B_bar = ((Lam_bar - 1.0) / Lam)[:, None] * Bmat
        Bu = torch.einsum("bld,pd->blp", x + 0j, B_bar)
        h = torch.zeros_like(Bu[:, 0, :])
        hs = []
        for t in range(L):
            h = Lam_bar[None, :] * h + Bu[:, t, :]
            hs.append(h)
        hseq = torch.stack(hs, 1)
        y = 2.0 * torch.einsum("blp,dp->bld", hseq, Cmat).real + x * Dskip[None, None, :]
        return y

    def _B_ref(x, w_gate, w_up, w_down):
        return (_gelu(x @ w_gate) * (x @ w_up)) @ w_down

    x = A_x
    xn = _layernorm(x, axis=-1)
    return x + _A_ref(xn, A_Lambda_re, A_Lambda_im, A_B_re, A_B_im, A_C_re, A_C_im, A_log_dt, A_Dskip) + _B_ref(xn, B_w_gate, B_w_up, B_w_down)
```

```asm
; @launch grid=(256,1,1) block=(256,1,1) lds=153600
.amdgcn_target "amdgcn-amd-amdhsa--gfx950"
.text
.globl parallel_sum__ssm_conv_s5__geglu_ffn__prompt_kernel
.p2align 8
.type parallel_sum__ssm_conv_s5__geglu_ffn__prompt_kernel,@function
parallel_sum__ssm_conv_s5__geglu_ffn__prompt_kernel:
  s_cmpk_ge_u32 s2, 0x100
  s_cbranch_scc1 Lend
  s_load_dwordx16 s[16:31], s[0:1], 0
  s_load_dwordx16 s[32:47], s[0:1], 64
  v_lshrrev_b32 v64, 6, v0
  v_and_b32 v65, 63, v0
  v_readfirstlane_b32 s4, v64
  s_lshr_b32 s11, s2, 3
  s_getpc_b64 s[0:1]
Lpc:
  s_lshl2_add_u32 s12, s11, s4
  s_lshl_b32 s12, s12, 8
  v_lshlrev_b32 v29, 7, v65
  v_add_u32_e64 v66, s12, v29
  v_min_u32 v66, Lcode_end-Lmain-4, v66
  v_add_u32 v66, Lmain-Lpc, v66
  s_mov_b64 exec, 3
  s_lshr_b32 s3, s2, 1
  global_load_dword a39, v66, s[0:1]
  s_mov_b64 exec, -1
  s_and_b32 s3, s3, 3
  s_and_b32 s12, s11, 3
  s_lshl2_add_u32 s5, s3, s12
  s_and_b32 s7, s2, 1
  s_lshr_b32 s8, s11, 2
  s_lshl3_add_u32 s6, s7, s8
  s_lshl2_add_u32 s12, s5, s4
  s_lshl_b32 s3, s12, 15
  v_lshrrev_b32 v66, 3, v65
  v_and_b32 v67, 7, v65
  v_lshrrev_b32 v68, 4, v65
  v_xor_b32 v68, v67, v68
  v_lshlrev_b32 v68, 4, v68
  v_lshrrev_b32_e64 v74, 5, v65
  v_mad_u32_u24 v119, v74, 4, v66
  v_lshl_add_u32 v120, v119, 10, v68
  v_add_u32_e64 v120, s3, v120
  s_and_b32 s3, s6, 3
  s_lshl_b32 s86, s3, 8
  v_add_u32 v0, s86, v120
  s_mul_i32 s13, s4, 4352
  s_add_u32 m0, s13, 69632
  s_movk_i32 s80, 15296
  s_movk_i32 s81, 1920
  s_movk_i32 s82, 17216
  s_movk_i32 s83, 7104
  s_movk_i32 s84, 14208
  s_movk_i32 s85, 21312
  s_mov_b32 s51, 0x20000
  s_mov_b32 s55, s51
  s_lshl_b32 s50, s51, 4
  s_lshl_b32 s54, s51, 2
  v_lshl_add_u32 v93, v66, 10, v68
  s_and_b32 s9, s4, 1
  s_lshl_b32 s3, s6, 8
  s_add_u32 s3, s3, s9
  s_lshl_b32 s3, s3, 7
  v_add_u32_e64 v28, s3, v93
  v_add_u32 v13, 128, v0
  v_and_b32 v71, 31, v65
  s_lshl_b32 s11, s6, 5
  v_add_lshl_u32 v72, v71, s11, 1
  v_mov_b32 v73, 0
  s_andn2_b32 s3, s2, 1
  s_add_u32 s3, s3, s9
  s_lshl_b32 s11, s7, 8
  s_add_u32 s3, s3, s11
  s_lshl_b32 s15, s3, 10
  s_cmp_ge_u32 s4, 2
  s_waitcnt lgkmcnt(0)
  s_mov_b64 s[48:49], s[16:17]
  s_cselect_b64 s[52:53], s[24:25], s[22:23]
  buffer_load_dwordx4 v0, s[48:51], 0 offen lds
  buffer_load_dwordx4 v0, s[48:51], s80 offen offset:1088 lds
  buffer_load_dwordx4 v0, s[48:51], s81 offen offset:2176 lds
  buffer_load_dwordx4 v0, s[48:51], s82 offen offset:3264 lds
  s_add_u32 m0, s13, 87040
  global_load_ushort v80, v72, s[18:19]
  global_load_ushort v81, v72, s[20:21]
  global_load_ushort v82, v72, s[30:31]
  global_load_dword v83, v73, s[46:47] sc1
  global_load_dword v117, v73, s[16:17]
  buffer_load_dwordx4 v13, s[48:51], 0 offen lds
  buffer_load_dwordx4 v13, s[48:51], s80 offen offset:1088 lds
  buffer_load_dwordx4 v13, s[48:51], s81 offen offset:2176 lds
  buffer_load_dwordx4 v13, s[48:51], s82 offen offset:3264 lds
  s_mov_b64 exec, 0xff
  buffer_load_dword a32, v29, s[52:55], s15 offen
  s_mov_b64 exec, -1
  s_branch Lmain
.p2align 12
Lmain:
  s_cmp_ge_u32 s4, 2
  s_cselect_b64 s[56:57], s[38:39], s[36:37]
  s_mov_b64 s[60:61], s[26:27]
  s_mov_b64 s[64:65], s[28:29]
  s_mov_b64 s[68:69], s[40:41]
  s_mov_b64 s[72:73], s[46:47]
  s_mov_b64 s[76:77], s[42:43]
  s_nop 0
  s_add_u32 s28, s13, 69632
  s_mov_b32 s46, s13
  v_add_u32 v121, 128, v120
  s_xor_b32 s8, s8, 3
  s_xor_b32 s8, s8, s7
  s_lshl1_add_u32 s7, s5, s7
  s_add_u32 s87, s86, 256
  s_and_b32 s87, s87, 0x300
  s_add_u32 s88, s87, 256
  s_and_b32 s88, s88, 0x300
  s_add_u32 s89, s88, 256
  s_and_b32 s89, s89, 0x300
  s_mov_b32 s58, 1409024
  s_mov_b32 s59, s51
  s_mov_b32 s62, s54
  s_mov_b32 s63, s51
  s_mov_b32 s66, s54
  v_add_u32 v0, s87, v120
  s_add_u32 m0, s28, 34816
  s_nop 0
  buffer_load_dwordx4 v0, s[48:51], 0 offen lds
  s_mov_b32 s67, s51
  s_mov_b32 s70, s58
  s_mov_b32 s71, s51
  s_mov_b32 s74, 21037056
  s_mov_b32 s75, s51
  s_lshl_b32 s78, s51, 5
  s_mov_b32 s79, s51
  s_mul_i32 s29, s4, 4160
  s_mov_b32 s90, 87040
  s_movk_i32 s91, 19904
  s_mov_b32 s92, 106944
  s_mov_b32 s16, 0xffff0000
  s_mov_b32 s17, 0x3f803f80
  s_mov_b32 s100, 0
  v_lshlrev_b32 v1, 4, v65
  v_bfe_u32 v79, v65, 3, 1
  v_lshrrev_b32 v84, 4, v65
  v_mul_u32_u24 v69, 1088, v79
  v_lshl_add_u32 v69, v67, 7, v69
  v_bfe_u32 v75, v65, 1, 2
  v_xor_b32_e64 v75, v75, v84
  v_lshl_add_u32 v26, v75, 4, v69
  v_add_u32 v27, 2176, v26
  v_add_u32 v6, s28, v26
  buffer_load_dwordx4 v0, s[48:51], s80 offen offset:1088 lds
  v_mov_b32 v88, 0
  v_mov_b32 v89, 0
  v_mov_b32 v90, 0
  v_mov_b32 v91, 0
  v_add_u32 v25, s46, v26
  v_lshlrev_b32 v24, 2, v71
  v_add_u32 v24, 152576, v24
  s_and_b32 s3, s4, 1
  s_mul_i32 s11, s3, 176128
  s_mul_i32 s22, s86, 1376
  s_mul_i32 s23, s87, 1376
  s_mul_i32 s24, s88, 1376
  s_mul_i32 s25, s89, 1376
  s_cmp_eq_u32 s3, 1
  s_cselect_b32 s26, s23, s22
  s_cselect_b32 s27, s25, s24
  s_add_u32 s22, s22, s11
  s_add_u32 s23, s23, s11
  s_add_u32 s24, s24, s11
  s_add_u32 s25, s25, s11
  s_lshl_b32 s3, s8, 16
  s_lshl_b32 s11, s4, 8
  s_add_u32 s3, s3, s11
  v_add_u32 v2, s3, v93
  buffer_load_dwordx4 v0, s[48:51], s81 offen offset:2176 lds
  v_and_b32 v85, 1, v84
  v_lshlrev_b32 v69, 1, v85
  v_xor_b32 v69, v67, v69
  v_lshlrev_b32 v69, 4, v69
  s_lshl_b32 s3, s8, 7
  v_lshl_add_u32 v3, v119, 10, v69
  v_add_u32_e64 v3, s3, v3
  s_mov_b32 s98, 0x11111110
  s_mov_b32 s99, 0x55543211
  s_lshl_b32 s3, s6, 2
  s_lshr_b64 s[96:97], s[98:99], s3
  s_and_b32 s94, s96, 7
  s_mul_i32 s3, s6, 3
  s_sub_u32 s3, s3, s94
  s_and_b32 s9, s3, 1
  s_lshl_b32 s9, s9, 6
  s_lshl_b32 s3, s3, 6
  s_add_u32 s11, s3, s9
  v_mul_u32_u24 v4, 5504, v119
  v_xor_b32 v70, s9, v69
  v_add3_u32 v4, v4, v70, s11
  s_lshl_b32 s13, s9, 1
  s_sub_u32 s30, 2816, s13
  s_add_u32 s11, s3, s13
  buffer_load_dwordx4 v0, s[48:51], s82 offen offset:3264 lds
  s_add_u32 s11, s11, 2752
  v_lshrrev_b32 v92, 2, v65
  v_mul_u32_u24 v5, 5504, v92
  v_and_b32 v69, 0x30, v69
  v_add3_u32 v5, v5, v69, s11
  v_and_b32_e64 v70, 3, v65
  s_lshl_b32 s13, s13, 1
  s_sub_u32 s45, -2624, s13
  s_bitcmp0_b32 0x1e01, s6
  s_cselect_b32 s45, s45, 1073741824
  v_lshlrev_b32_e64 v75, 3, v70
  v_bfe_u32 v76, v65, 2, 2
  v_lshl_add_u32 v77, v85, 5, v75
  v_lshl_add_u32 v12, v92, 6, v77
  v_xor_b32_e64 v7, 32, v12
  v_lshl_add_u32 v77, v74, 2, v76
  v_lshl_add_u32 v78, v77, 7, v75
  v_lshl_add_u32 v78, v79, 5, v78
  v_mul_u32_u24 v77, 1088, v85
  v_add3_u32 v8, v78, v77, s28
  v_xor_b32_e64 v9, 32, v8
  v_mul_u32_u24 v77, 2112, v85
  v_add_u32_e64 v10, v78, v77
  v_xor_b32_e64 v11, 32, v10
  v_lshl_add_u32 v78, v74, 2, v70
  v_lshl_add_u32 v78, v76, 3, v78
  v_lshlrev_b32 v77, 4, v67
  v_lshl_add_u32 v77, v66, 10, v77
  v_accvgpr_write_b32 a53, v77
  s_lshl_b32 s3, s4, 5
  v_add_lshl_u32 v123, v78, s3, 3
  v_add_u32 v123, 151552, v123
  v_lshl_add_u32 v22, s4, 1, v74
  v_lshlrev_b32 v17, 7, v22
  v_add_u32 v17, 151552, v17
  v_lshlrev_b32 v86, 4, v71
  v_add_u32 v23, 147456, v86
  v_lshl_add_u32 v16, v74, 3, v23
  s_lshl_b32 s3, s4, 9
  v_add_u32 v16, s3, v16
  v_accvgpr_write_b32 a48, v16
  v_accvgpr_write_b32 a49, v23
  v_lshlrev_b32_e64 v87, 1, v22
  v_lshl_add_u32 v86, v87, 9, v86
  v_add_u32 v77, 512, v86
  v_cmp_gt_u32 s[20:21], s5, v87
  v_add_u32 v78, 1, v87
  v_cmp_gt_u32 s[18:19], s5, v78
  v_mov_b32_e64 v78, 1073741824
  s_lshl_b32 s3, s4, 11
  s_add_u32 s3, s3, 139264
  v_cndmask_b32 v86, v78, v86, s[20:21]
  v_cndmask_b32 v77, v78, v77, s[18:19]
  v_accvgpr_write_b32 a46, v86
  v_accvgpr_write_b32 a47, v77
  v_bfe_u32 v77, v65, 1, 2
  v_lshlrev_b32 v78, 1, v74
  v_xor_b32 v77, v77, v78
  v_lshl_add_u32 v77, v77, 4, s3
  v_lshl_add_u32 v77, v71, 6, v77
  v_accvgpr_write_b32 a50, v77
  v_lshl_add_u32 v77, v84, 3, v76
  v_xor_b32_e64 v78, v70, v79
  v_lshl_add_u32 v78, v78, 4, s3
  v_lshl_add_u32 v77, v77, 6, v78
  v_accvgpr_write_b32 a51, v77
  v_xor_b32 v78, v84, v76
  v_min_u32 v78, 1, v78
  v_xor_b32 v78, 1, v78
  v_lshlrev_b32 v78, v70, v78
  v_bfe_i32 v94, v78, 0, 1
  v_and_b32 v95, 0x3f80, v94
  v_and_b32_e64 v94, 1.0, v94
  v_accvgpr_write_b32 a240, v95
  v_accvgpr_write_b32 a244, v94
  v_bfe_i32 v94, v78, 1, 1
  v_and_b32 v95, 0x3f80, v94
  v_and_b32_e64 v94, 1.0, v94
  v_accvgpr_write_b32 a241, v95
  v_accvgpr_write_b32 a245, v94
  v_bfe_i32 v94, v78, 2, 1
  v_and_b32 v95, 0x3f80, v94
  v_and_b32_e64 v94, 1.0, v94
  v_accvgpr_write_b32 a242, v95
  v_accvgpr_write_b32 a246, v94
  v_bfe_i32 v94, v78, 3, 1
  v_and_b32 v95, 0x3f80, v94
  v_and_b32_e64 v94, 1.0, v94
  v_accvgpr_write_b32 a243, v95
  v_accvgpr_write_b32 a247, v94
  v_mov_b32_e64 v94, s17
  v_accvgpr_write_b32 a248, v94
  v_accvgpr_write_b32 a249, v94
  v_accvgpr_write_b32 a250, v94
  v_accvgpr_write_b32 a251, v94
  s_mov_b64 exec, 0
  s_cmp_eq_u32 s4, 0
  s_cbranch_scc1 Lpad1
  s_cmp_eq_u32 s4, 1
  s_cbranch_scc1 Lpad2
Lret1:
Lret2:
  s_mov_b64 exec, -1
  v_add_u32 v0, s87, v121
  s_add_u32 m0, s28, 52224
  s_nop 0
  buffer_load_dwordx4 v0, s[48:51], 0 offen lds
  buffer_load_dwordx4 v0, s[48:51], s80 offen offset:1088 lds
  buffer_load_dwordx4 v0, s[48:51], s81 offen offset:2176 lds
  buffer_load_dwordx4 v0, s[48:51], s82 offen offset:3264 lds
  s_waitcnt vmcnt(18)
  ds_read_b128 v[128:131], v6 offset:0
  ds_read_b128 v[132:135], v6 offset:2176
  ds_read_b128 v[136:139], v6 offset:64
  ds_read_b128 v[140:143], v6 offset:2240
  s_waitcnt vmcnt(17)
  v_lshlrev_b32 v80, 16, v80
  s_waitcnt vmcnt(16)
  v_lshlrev_b32 v81, 16, v81
  s_waitcnt vmcnt(15)
  v_lshlrev_b32 v82, 16, v82
  s_waitcnt vmcnt(13)
  v_mul_u32_u24 v118, 0x5ebca6, v117
  v_xor_b32 v117, v117, v118
  v_lshl_add_u32 v83, v117, 1, v83
  v_mul_f32 v82, 0x3fb8aa3b, v82
  v_readfirstlane_b32 s10, v83
  v_exp_f32_e64 v82, v82
  s_add_u32 s10, s10, 0x9e3779b9
  v_cvt_pk_bf16_f32 v82, v82, v82
  v_lshlrev_b32 v82, 16, v82
  v_mul_f32 v64, v82, v80
  v_mul_f32 v65, v82, v81
  s_waitcnt vmcnt(9)
  ds_read_b128 v[144:147], v6 offset:17408
  ds_read_b128 v[148:151], v6 offset:19584
  ds_read_b128 v[152:155], v6 offset:17472
  ds_read_b128 v[156:159], v6 offset:19648
  s_waitcnt lgkmcnt(4)
  v_add_u32 v0, s88, v120
  s_add_u32 m0, s28, 0
  s_nop 0
  buffer_load_dwordx4 v0, s[48:51], 0 offen lds
  v_dot2c_f32_bf16 v88, s17, v128
  v_dot2c_f32_bf16 v90, v128, v128
  v_dot2c_f32_bf16 v89, s17, v132
  v_dot2c_f32_bf16 v91, v132, v132
  v_dot2c_f32_bf16 v88, s17, v129
  v_dot2c_f32_bf16 v90, v129, v129
  v_dot2c_f32_bf16 v89, s17, v133
  v_dot2c_f32_bf16 v91, v133, v133
  buffer_load_dwordx4 v0, s[48:51], s80 offen offset:1088 lds
  v_dot2c_f32_bf16 v88, s17, v130
  v_dot2c_f32_bf16 v90, v130, v130
  v_dot2c_f32_bf16 v89, s17, v134
  v_dot2c_f32_bf16 v91, v134, v134
  v_dot2c_f32_bf16 v88, s17, v131
  v_dot2c_f32_bf16 v90, v131, v131
  v_dot2c_f32_bf16 v89, s17, v135
  v_dot2c_f32_bf16 v91, v135, v135
  buffer_load_dwordx4 v0, s[48:51], s81 offen offset:2176 lds
  v_dot2c_f32_bf16 v88, s17, v136
  v_dot2c_f32_bf16 v90, v136, v136
  v_dot2c_f32_bf16 v89, s17, v140
  v_dot2c_f32_bf16 v91, v140, v140
  v_dot2c_f32_bf16 v88, s17, v137
  v_dot2c_f32_bf16 v90, v137, v137
  v_dot2c_f32_bf16 v89, s17, v141
  v_dot2c_f32_bf16 v91, v141, v141
  buffer_load_dwordx4 v0, s[48:51], s82 offen offset:3264 lds
  v_dot2c_f32_bf16 v88, s17, v138
  v_dot2c_f32_bf16 v90, v138, v138
  v_dot2c_f32_bf16 v89, s17, v142
  v_dot2c_f32_bf16 v91, v142, v142
  v_dot2c_f32_bf16 v88, s17, v139
  v_dot2c_f32_bf16 v90, v139, v139
  v_dot2c_f32_bf16 v89, s17, v143
  v_dot2c_f32_bf16 v91, v143, v143
  v_mul_f32 v64, 0x3fb8aa3b, v64
  v_mul_f32 v65, 0.15915494, v65
  v_mul_f32 v66, 1.0, v64
  v_mul_f32 v67, 1.0, v65
  v_exp_f32 v66, v66
  v_rndne_f32 v14, v67
  v_sub_f32 v67, v67, v14
  v_cos_f32 v14, v67
  v_sin_f32 v15, v67
  v_mul_f32_e64 v14, v14, v66
  v_mul_f32 v15, v15, v66
  v_mul_f32 v66, 0x41800000, v64
  v_mul_f32 v67, 0x41800000, v65
  v_exp_f32_e64 v66, v66
  s_waitcnt vmcnt(8)
  ds_read_b128 v[160:163], v6 offset:34816
  ds_read_b128 v[164:167], v6 offset:36992
  ds_read_b128 v[168:171], v6 offset:34880
  ds_read_b128 v[172:175], v6 offset:37056
  s_waitcnt lgkmcnt(4)
  v_add_u32_e64 v0, s88, v121
  s_add_u32 m0, s28, 17408
  s_nop 0
  buffer_load_dwordx4 v0, s[48:51], 0 offen lds
  v_dot2c_f32_bf16 v88, s17, v144
  v_dot2c_f32_bf16 v90, v144, v144
  v_dot2c_f32_bf16 v89, s17, v148
  v_dot2c_f32_bf16 v91, v148, v148
  v_dot2c_f32_bf16 v88, s17, v145
  v_dot2c_f32_bf16 v90, v145, v145
  v_dot2c_f32_bf16 v89, s17, v149
  v_dot2c_f32_bf16 v91, v149, v149
  buffer_load_dwordx4 v0, s[48:51], s80 offen offset:1088 lds
  v_dot2c_f32_bf16 v88, s17, v146
  v_dot2c_f32_bf16 v90, v146, v146
  v_dot2c_f32_bf16 v89, s17, v150
  v_dot2c_f32_bf16 v91, v150, v150
  v_dot2c_f32_bf16 v88, s17, v147
  v_dot2c_f32_bf16 v90, v147, v147
  v_dot2c_f32_bf16 v89, s17, v151
  v_dot2c_f32_bf16 v91, v151, v151
  buffer_load_dwordx4 v0, s[48:51], s81 offen offset:2176 lds
  v_dot2c_f32_bf16 v88, s17, v152
  v_dot2c_f32_bf16 v90, v152, v152
  v_dot2c_f32_bf16 v89, s17, v156
  v_dot2c_f32_bf16 v91, v156, v156
  v_dot2c_f32_bf16 v88, s17, v153
  v_dot2c_f32_bf16 v90, v153, v153
  v_dot2c_f32_bf16 v89, s17, v157
  v_dot2c_f32_bf16 v91, v157, v157
  buffer_load_dwordx4 v0, s[48:51], s82 offen offset:3264 lds
  v_dot2c_f32_bf16 v88, s17, v154
  v_dot2c_f32_bf16 v90, v154, v154
  v_dot2c_f32_bf16 v89, s17, v158
  v_dot2c_f32_bf16 v91, v158, v158
  v_dot2c_f32_bf16 v88, s17, v155
  v_dot2c_f32_bf16 v90, v155, v155
  v_dot2c_f32_bf16 v89, s17, v159
  v_dot2c_f32_bf16 v91, v159, v159
  v_rndne_f32 v18, v67
  v_sub_f32 v67, v67, v18
  v_cos_f32 v18, v67
  v_sin_f32 v19, v67
  v_mul_f32 v18, v18, v66
  v_mul_f32 v19, v19, v66
  v_mul_f32 v66, v80, v80
  v_fmac_f32 v66, v81, v81
  v_rcp_f32 v66, v66
  v_add_f32 v67, -1.0, v14
  v_mul_f32 v20, v67, v80
  v_fmac_f32_e64 v20, v15, v81
  v_mul_f32_e64 v21, v15, v80
  v_fma_f32 v21, -v67, v81, v21
  s_waitcnt vmcnt(8)
  ds_read_b128 v[176:179], v6 offset:52224
  ds_read_b128 v[180:183], v6 offset:54400
  ds_read_b128 v[184:187], v6 offset:52288
  ds_read_b128 v[188:191], v6 offset:54464
  s_waitcnt lgkmcnt(4)
  v_add_u32_e64 v0, s89, v120
  s_add_u32 m0, s28, 34816
  s_nop 0
  buffer_load_dwordx4 v0, s[48:51], 0 offen lds
  v_dot2c_f32_bf16 v88, s17, v160
  v_dot2c_f32_bf16 v90, v160, v160
  v_dot2c_f32_bf16 v89, s17, v164
  v_dot2c_f32_bf16 v91, v164, v164
  v_dot2c_f32_bf16 v88, s17, v161
  v_dot2c_f32_bf16 v90, v161, v161
  v_dot2c_f32_bf16 v89, s17, v165
  v_dot2c_f32_bf16 v91, v165, v165
  buffer_load_dwordx4 v0, s[48:51], s80 offen offset:1088 lds
  v_dot2c_f32_bf16 v88, s17, v162
  v_dot2c_f32_bf16 v90, v162, v162
  v_dot2c_f32_bf16 v89, s17, v166
  v_dot2c_f32_bf16 v91, v166, v166
  v_dot2c_f32_bf16 v88, s17, v163
  v_dot2c_f32_bf16 v90, v163, v163
  v_dot2c_f32_bf16 v89, s17, v167
  v_dot2c_f32_bf16 v91, v167, v167
  buffer_load_dwordx4 v0, s[48:51], s81 offen offset:2176 lds
  v_dot2c_f32_bf16 v88, s17, v168
  v_dot2c_f32_bf16 v90, v168, v168
  v_dot2c_f32_bf16 v89, s17, v172
  v_dot2c_f32_bf16 v91, v172, v172
  v_dot2c_f32_bf16 v88, s17, v169
  v_dot2c_f32_bf16 v90, v169, v169
  v_dot2c_f32_bf16 v89, s17, v173
  v_dot2c_f32_bf16 v91, v173, v173
  buffer_load_dwordx4 v0, s[48:51], s82 offen offset:3264 lds
  v_dot2c_f32_bf16 v88, s17, v170
  v_dot2c_f32_bf16 v90, v170, v170
  v_dot2c_f32_bf16 v89, s17, v174
  v_dot2c_f32_bf16 v91, v174, v174
  v_dot2c_f32_bf16 v88, s17, v171
  v_dot2c_f32_bf16 v90, v171, v171
  v_dot2c_f32_bf16 v89, s17, v175
  v_dot2c_f32_bf16 v91, v175, v175
  v_add_f32 v66, v66, v66
  v_mul_f32 v20, v20, v66
  v_mul_f32 v21, v21, v66
  v_lshlrev_b32 v68, 4, v22
  v_cvt_f32_u32 v68, v68
  v_mul_f32 v66, v68, v64
  v_mul_f32 v67, v68, v65
  v_exp_f32 v66, v66
  v_rndne_f32 v69, v67
  v_sub_f32 v67, v67, v69
  v_cos_f32 v69, v67
  v_sin_f32_e64 v70, v67
  v_mul_f32_e64 v69, v69, v66
  v_mul_f32_e64 v70, v70, v66
  s_waitcnt vmcnt(8)
  ds_read_b128 v[192:195], v6 offset:0
  ds_read_b128 v[196:199], v6 offset:2176
  ds_read_b128 v[200:203], v6 offset:64
  ds_read_b128 v[204:207], v6 offset:2240
  s_waitcnt lgkmcnt(4)
  v_add_u32_e64 v0, s89, v121
  s_add_u32 m0, s28, 52224
  s_nop 0
  buffer_load_dwordx4 v0, s[48:51], 0 offen lds
  v_dot2c_f32_bf16 v88, s17, v176
  v_dot2c_f32_bf16 v90, v176, v176
  v_dot2c_f32_bf16 v89, s17, v180
  v_dot2c_f32_bf16 v91, v180, v180
  v_dot2c_f32_bf16 v88, s17, v177
  v_dot2c_f32_bf16 v90, v177, v177
  v_dot2c_f32_bf16 v89, s17, v181
  v_dot2c_f32_bf16 v91, v181, v181
  buffer_load_dwordx4 v0, s[48:51], s80 offen offset:1088 lds
  v_dot2c_f32_bf16 v88, s17, v178
  v_dot2c_f32_bf16 v90, v178, v178
  v_dot2c_f32_bf16 v89, s17, v182
  v_dot2c_f32_bf16 v91, v182, v182
  v_dot2c_f32_bf16 v88, s17, v179
  v_dot2c_f32_bf16 v90, v179, v179
  v_dot2c_f32_bf16 v89, s17, v183
  v_dot2c_f32_bf16 v91, v183, v183
  buffer_load_dwordx4 v0, s[48:51], s81 offen offset:2176 lds
  v_dot2c_f32_bf16 v88, s17, v184
  v_dot2c_f32_bf16 v90, v184, v184
  v_dot2c_f32_bf16 v89, s17, v188
  v_dot2c_f32_bf16 v91, v188, v188
  v_dot2c_f32_bf16 v88, s17, v185
  v_dot2c_f32_bf16 v90, v185, v185
  v_dot2c_f32_bf16 v89, s17, v189
  v_dot2c_f32_bf16 v91, v189, v189
  buffer_load_dwordx4 v0, s[48:51], s82 offen offset:3264 lds
  v_dot2c_f32_bf16 v88, s17, v186
  v_dot2c_f32_bf16 v90, v186, v186
  v_dot2c_f32_bf16 v89, s17, v190
  v_dot2c_f32_bf16 v91, v190, v190
  v_dot2c_f32_bf16 v88, s17, v187
  v_dot2c_f32_bf16 v90, v187, v187
  v_dot2c_f32_bf16 v89, s17, v191
  v_dot2c_f32_bf16 v91, v191, v191
  v_mul_f32 v71, v69, v20
  v_mul_f32 v72, v69, v21
  v_fma_f32 v71, -v70, v21, v71
  v_fmac_f32 v72, v70, v20
  v_sub_u32 v68, s5, v87
  v_accvgpr_write_b32 a40, v71
  v_accvgpr_write_b32 a41, v72
  v_add_u32 v69, -1, v68
  v_add_u32 v70, -2, v68
  v_max_i32 v69, 0, v69
  v_max_i32 v70, 0, v70
  v_lshlrev_b32 v69, 7, v69
  v_lshlrev_b32 v70, 7, v70
  v_cvt_f32_u32 v69, v69
  s_waitcnt vmcnt(8)
  ds_read_b128 v[208:211], v6 offset:17408
  ds_read_b128 v[212:215], v6 offset:19584
  ds_read_b128 v[216:219], v6 offset:17472
  ds_read_b128 v[220:223], v6 offset:19648
  s_waitcnt lgkmcnt(4)
  v_add_u32 v0, s86, v28
  s_add_u32 m0, s46, 0
  s_nop 0
  buffer_load_dwordx4 v0, s[52:55], 0 offen lds
  v_dot2c_f32_bf16 v88, s17, v192
  v_dot2c_f32_bf16 v90, v192, v192
  v_dot2c_f32_bf16 v89, s17, v196
  v_dot2c_f32_bf16 v91, v196, v196
  v_dot2c_f32_bf16 v88, s17, v193
  v_dot2c_f32_bf16 v90, v193, v193
  v_dot2c_f32_bf16 v89, s17, v197
  v_dot2c_f32_bf16 v91, v197, v197
  buffer_load_dwordx4 v0, s[52:55], s83 offen offset:1088 lds
  v_dot2c_f32_bf16 v88, s17, v194
  v_dot2c_f32_bf16 v90, v194, v194
  v_dot2c_f32_bf16 v89, s17, v198
  v_dot2c_f32_bf16 v91, v198, v198
  v_dot2c_f32_bf16 v88, s17, v195
  v_dot2c_f32_bf16 v90, v195, v195
  v_dot2c_f32_bf16 v89, s17, v199
  v_dot2c_f32_bf16 v91, v199, v199
  buffer_load_dwordx4 v0, s[52:55], s84 offen offset:2176 lds
  v_dot2c_f32_bf16 v88, s17, v200
  v_dot2c_f32_bf16 v90, v200, v200
  v_dot2c_f32_bf16 v89, s17, v204
  v_dot2c_f32_bf16 v91, v204, v204
  v_dot2c_f32_bf16 v88, s17, v201
  v_dot2c_f32_bf16 v90, v201, v201
  v_dot2c_f32_bf16 v89, s17, v205
  v_dot2c_f32_bf16 v91, v205, v205
  buffer_load_dwordx4 v0, s[52:55], s85 offen offset:3264 lds
  v_dot2c_f32_bf16 v88, s17, v202
  v_dot2c_f32_bf16 v90, v202, v202
  v_dot2c_f32_bf16 v89, s17, v206
  v_dot2c_f32_bf16 v91, v206, v206
  v_dot2c_f32_bf16 v88, s17, v203
  v_dot2c_f32_bf16 v90, v203, v203
  v_dot2c_f32_bf16 v89, s17, v207
  v_dot2c_f32_bf16 v91, v207, v207
  v_cvt_f32_u32 v70, v70
  v_mul_f32 v66, v69, v64
  v_mul_f32 v67, v69, v65
  v_exp_f32 v66, v66
  v_rndne_f32 v71, v67
  v_sub_f32 v67, v67, v71
  v_cos_f32 v71, v67
  v_sin_f32 v72, v67
  v_mul_f32_e64 v71, v71, v66
  v_mul_f32_e64 v72, v72, v66
  v_mul_f32 v66, v70, v64
  v_mul_f32_e64 v67, v70, v65
  v_exp_f32_e64 v66, v66
  v_rndne_f32_e64 v73, v67
  s_waitcnt vmcnt(8)
  ds_read_b128 v[224:227], v6 offset:34816
  ds_read_b128 v[228:231], v6 offset:36992
  ds_read_b128 v[232:235], v6 offset:34880
  ds_read_b128 v[236:239], v6 offset:37056
  s_waitcnt lgkmcnt(4)
  v_add_u32_e64 v0, s87, v28
  s_add_u32 m0, s46, 17408
  s_nop 0
  buffer_load_dwordx4 v0, s[52:55], 0 offen lds
  v_dot2c_f32_bf16 v88, s17, v208
  v_dot2c_f32_bf16 v90, v208, v208
  v_dot2c_f32_bf16 v89, s17, v212
  v_dot2c_f32_bf16 v91, v212, v212
  v_dot2c_f32_bf16 v88, s17, v209
  v_dot2c_f32_bf16 v90, v209, v209
  v_dot2c_f32_bf16 v89, s17, v213
  v_dot2c_f32_bf16 v91, v213, v213
  buffer_load_dwordx4 v0, s[52:55], s83 offen offset:1088 lds
  v_dot2c_f32_bf16 v88, s17, v210
  v_dot2c_f32_bf16 v90, v210, v210
  v_dot2c_f32_bf16 v89, s17, v214
  v_dot2c_f32_bf16 v91, v214, v214
  v_dot2c_f32_bf16 v88, s17, v211
  v_dot2c_f32_bf16 v90, v211, v211
  v_dot2c_f32_bf16 v89, s17, v215
  v_dot2c_f32_bf16 v91, v215, v215
  buffer_load_dwordx4 v0, s[52:55], s84 offen offset:2176 lds
  v_dot2c_f32_bf16 v88, s17, v216
  v_dot2c_f32_bf16 v90, v216, v216
  v_dot2c_f32_bf16 v89, s17, v220
  v_dot2c_f32_bf16 v91, v220, v220
  v_dot2c_f32_bf16 v88, s17, v217
  v_dot2c_f32_bf16 v90, v217, v217
  v_dot2c_f32_bf16 v89, s17, v221
  v_dot2c_f32_bf16 v91, v221, v221
  buffer_load_dwordx4 v0, s[52:55], s85 offen offset:3264 lds
  v_dot2c_f32_bf16 v88, s17, v218
  v_dot2c_f32_bf16 v90, v218, v218
  v_dot2c_f32_bf16 v89, s17, v222
  v_dot2c_f32_bf16 v91, v222, v222
  v_dot2c_f32_bf16 v88, s17, v219
  v_dot2c_f32_bf16 v90, v219, v219
  v_dot2c_f32_bf16 v89, s17, v223
  v_dot2c_f32_bf16 v91, v223, v223
  v_sub_f32 v67, v67, v73
  v_cos_f32 v73, v67
  v_sin_f32 v74, v67
  v_mul_f32 v73, v73, v66
  v_mul_f32 v74, v74, v66
  v_accvgpr_write_b32 a42, v71
  v_accvgpr_write_b32 a43, v72
  v_accvgpr_write_b32 a44, v73
  v_accvgpr_write_b32 a45, v74
  s_waitcnt vmcnt(8)
  ds_read_b128 v[240:243], v6 offset:52224
  ds_read_b128 v[244:247], v6 offset:54400
  ds_read_b128 v[248:251], v6 offset:52288
  ds_read_b128 v[252:255], v6 offset:54464
  s_waitcnt lgkmcnt(4)
  v_add_u32 v0, s88, v28
  s_add_u32 m0, s46, 34816
  s_nop 0
  buffer_load_dwordx4 v0, s[52:55], 0 offen lds
  v_dot2c_f32_bf16 v88, s17, v224
  v_dot2c_f32_bf16 v90, v224, v224
  v_dot2c_f32_bf16 v89, s17, v228
  v_dot2c_f32_bf16 v91, v228, v228
  v_dot2c_f32_bf16 v88, s17, v225
  v_dot2c_f32_bf16 v90, v225, v225
  v_dot2c_f32_bf16 v89, s17, v229
  v_dot2c_f32_bf16 v91, v229, v229
  buffer_load_dwordx4 v0, s[52:55], s83 offen offset:1088 lds
  v_dot2c_f32_bf16 v88, s17, v226
  v_dot2c_f32_bf16 v90, v226, v226
  v_dot2c_f32_bf16 v89, s17, v230
  v_dot2c_f32_bf16 v91, v230, v230
  v_dot2c_f32_bf16 v88, s17, v227
  v_dot2c_f32_bf16 v90, v227, v227
  v_dot2c_f32_bf16 v89, s17, v231
  v_dot2c_f32_bf16 v91, v231, v231
  buffer_load_dwordx4 v0, s[52:55], s84 offen offset:2176 lds
  v_dot2c_f32_bf16 v88, s17, v232
  v_dot2c_f32_bf16 v90, v232, v232
  v_dot2c_f32_bf16 v89, s17, v236
  v_dot2c_f32_bf16 v91, v236, v236
  v_dot2c_f32_bf16 v88, s17, v233
  v_dot2c_f32_bf16 v90, v233, v233
  v_dot2c_f32_bf16 v89, s17, v237
  v_dot2c_f32_bf16 v91, v237, v237
  buffer_load_dwordx4 v0, s[52:55], s85 offen offset:3264 lds
  v_dot2c_f32_bf16 v88, s17, v234
  v_dot2c_f32_bf16 v90, v234, v234
  v_dot2c_f32_bf16 v89, s17, v238
  v_dot2c_f32_bf16 v91, v238, v238
  v_dot2c_f32_bf16 v88, s17, v235
  v_dot2c_f32_bf16 v90, v235, v235
  v_dot2c_f32_bf16 v89, s17, v239
  v_dot2c_f32_bf16 v91, v239, v239
  s_waitcnt lgkmcnt(0)
  v_dot2c_f32_bf16 v88, s17, v240
  v_dot2c_f32_bf16 v90, v240, v240
  v_dot2c_f32_bf16 v89, s17, v244
  v_dot2c_f32_bf16 v91, v244, v244
  v_dot2c_f32_bf16 v88, s17, v241
  v_dot2c_f32_bf16 v90, v241, v241
  v_dot2c_f32_bf16 v89, s17, v245
  v_dot2c_f32_bf16 v91, v245, v245
  v_dot2c_f32_bf16 v88, s17, v242
  v_dot2c_f32_bf16 v90, v242, v242
  v_dot2c_f32_bf16 v89, s17, v246
  v_dot2c_f32_bf16 v91, v246, v246
  v_dot2c_f32_bf16 v88, s17, v243
  v_dot2c_f32_bf16 v90, v243, v243
  v_dot2c_f32_bf16 v89, s17, v247
  v_dot2c_f32_bf16 v91, v247, v247
  v_dot2c_f32_bf16 v88, s17, v248
  v_dot2c_f32_bf16 v90, v248, v248
  v_dot2c_f32_bf16 v89, s17, v252
  v_dot2c_f32_bf16 v91, v252, v252
  v_dot2c_f32_bf16 v88, s17, v249
  v_dot2c_f32_bf16 v90, v249, v249
  v_dot2c_f32_bf16 v89, s17, v253
  v_dot2c_f32_bf16 v91, v253, v253
  v_dot2c_f32_bf16 v88, s17, v250
  v_dot2c_f32_bf16 v90, v250, v250
  v_dot2c_f32_bf16 v89, s17, v254
  v_dot2c_f32_bf16 v91, v254, v254
  v_dot2c_f32_bf16 v88, s17, v251
  v_dot2c_f32_bf16 v90, v251, v251
  v_dot2c_f32_bf16 v89, s17, v255
  v_dot2c_f32_bf16 v91, v255, v255
  s_waitcnt vmcnt(8)
  s_barrier
  ds_read_b128 a[0:3], v26 offset:0
  ds_read_b128 a[4:7], v27 offset:0
  ds_read_b128 a[8:11], v26 offset:8704
  ds_read_b128 a[12:15], v27 offset:8704
  ds_read_b128 a[16:19], v26 offset:64
  ds_read_b128 a[20:23], v27 offset:64
  ds_read_b128 a[24:27], v26 offset:8768
  v_add_u32 v0, s89, v28
  s_add_u32 m0, s46, 52224
  s_nop 0
  buffer_load_dwordx4 v0, s[52:55], 0 offen lds
  v_mov_b32 v31, v123
  v_permlane32_swap_b32 v88, v89
  v_permlane32_swap_b32 v90, v91
  v_add_f32 v108, v88, v89
  v_add_f32 v109, v88, v89
  v_add_f32 v110, v90, v91
  v_add_f32_e64 v111, v90, v91
  v_permlane16_swap_b32 v108, v109
  buffer_load_dwordx4 v0, s[52:55], s83 offen offset:1088 lds
  s_waitcnt lgkmcnt(3)
  v_mfma_f32_16x16x32_bf16 v[32:35], v[128:131], a[0:3], 0
  ds_read_b128 a[28:31], v27 offset:8768
  buffer_load_dwordx4 v0, s[52:55], s84 offen offset:2176 lds
  v_mfma_f32_16x16x32_bf16 v[36:39], v[132:135], a[0:3], 0
  v_permlane16_swap_b32 v110, v111
  v_add_f32 v108, v108, v109
  v_mul_f32 v108, 0xbb000000, v108
  v_cvt_pk_bf16_f32 v109, v108, v108
  v_mfma_f32_16x16x32_bf16 v[44:47], v[132:135], a[4:7], 0
  ds_read_b128 a[0:3], v26 offset:4352
  ds_read_b128 a[224:227], v25 offset:0
  v_mfma_f32_16x16x32_bf16 v[40:43], v[128:131], a[4:7], 0
  ds_read_b128 a[228:231], v25 offset:2176
  ds_read_b128 a[232:235], v25 offset:64
  ds_read_b128 a[236:239], v25 offset:2240
  v_lshlrev_b32_e64 v112, 16, v109
  v_lshlrev_b32_e64 v116, 16, v109
  v_lshlrev_b32_e64 v109, 16, v109
  v_mfma_f32_16x16x32_bf16 v[48:51], v[128:131], a[8:11], 0
  ds_read_b128 a[4:7], v27 offset:4352
  buffer_load_dwordx4 v0, s[52:55], s85 offen offset:3264 lds
  v_mfma_f32_16x16x32_bf16 v[52:55], v[132:135], a[8:11], 0
  v_permlane32_swap_b32 v112, v116
  v_mov_b32 v113, v112
  v_mov_b32 v117, v116
  v_mfma_f32_16x16x32_bf16 v[60:63], v[132:135], a[12:15], 0
  s_waitcnt lgkmcnt(6)
  ds_read_b128 a[8:11], v26 offset:13056
  v_mov_b32_e64 v114, v112
  v_mfma_f32_16x16x32_bf16 v[56:59], v[128:131], a[12:15], 0
  v_mov_b32_e64 v118, v116
  v_mov_b32_e64 v115, v112
  v_mfma_f32_16x16x32_bf16 v[32:35], v[136:139], a[16:19], v[32:35]
  s_lshl_b32 s31, s2, 2
  s_add_u32 s31, s31, s4
  ds_read_b128 a[12:15], v27 offset:13056
  v_mov_b32_e64 v119, v116
  v_mfma_f32_16x16x32_bf16 v[36:39], v[140:143], a[16:19], v[36:39]
  s_mul_i32 s31, s31, 512
  v_add_f32 v110, v110, v111
  v_mul_f32 v110, 0x3b000000, v110
  v_fma_f32 v110, -v108, v108, v110
  s_mov_b64 exec, 0xf
  buffer_load_dword a34, v29, s[60:63], s31 offen
  s_mov_b64 exec, -1
  s_lshl_b32 s31, s2, 2
  s_add_u32 s31, s31, s4
  s_mul_i32 s31, s31, 512
  s_mov_b64 exec, 0xf
  buffer_load_dword a35, v29, s[64:67], s31 offen
  s_mov_b64 exec, -1
  v_mfma_f32_16x16x32_bf16 v[44:47], v[140:143], a[20:23], v[44:47]
  s_lshl_b32 s31, s2, 1
  s_and_b32 s0, s4, 1
  s_add_u32 s31, s31, s0
  ds_read_b128 a[16:19], v26 offset:4416
  v_max_f32_e64 v110, 0, v110
  v_mfma_f32_16x16x32_bf16 v[40:43], v[136:139], a[20:23], v[40:43]
  s_mul_i32 s31, s31, 2816
  v_cvt_pk_bf16_f32 v110, v110, v110
  v_lshlrev_b32 v110, 16, v110
  s_mov_b64 exec, 0x3fffff
  buffer_load_dword a33, v29, s[56:59], s31 offen
  s_mov_b64 exec, -1
  s_waitcnt lgkmcnt(7)
  v_mfma_f32_16x16x32_bf16 v[120:123], a[248:251], a[224:227], 0
Lpad1:
  s_cbranch_execz Lret1
  v_add_f32 v110, 0x3727c5ac, v110
  v_cvt_pk_bf16_f32 v110, v110, v110
  s_waitcnt lgkmcnt(6)
  v_mfma_f32_16x16x32_bf16 v[124:127], a[248:251], a[228:231], 0
  v_lshlrev_b32_e64 v110, 16, v110
  v_mfma_f32_16x16x32_bf16 v[48:51], v[136:139], a[24:27], v[48:51]
  s_nop 0
  s_mov_b32 s80, 87040
  ds_read_b128 a[20:23], v27 offset:4416
  v_sqrt_f32 v110, v110
  v_mfma_f32_16x16x32_bf16 v[52:55], v[140:143], a[24:27], v[52:55]
  s_nop 0
  v_mfma_f32_16x16x32_bf16 v[60:63], v[140:143], a[28:31], v[60:63]
  ds_read_b128 a[24:27], v26 offset:13120
  v_cvt_pk_bf16_f32 v110, v110, v110
  v_mfma_f32_16x16x32_bf16 v[56:59], v[136:139], a[28:31], v[56:59]
  v_lshlrev_b32_e64 v110, 16, v110
  v_rcp_f32_e64 v108, v110
  s_waitcnt lgkmcnt(7)
  v_mfma_f32_16x16x32_bf16 v[120:123], a[248:251], a[232:235], v[120:123]
  s_waitcnt lgkmcnt(3)
  v_mul_f32_e64 v110, v110, v110
  v_mul_f32_e64 v109, v109, v108
  v_mfma_f32_16x16x32_bf16 v[124:127], a[248:251], a[236:239], v[124:127]
  v_accvgpr_write_b32 a56, v110
  v_mfma_f32_16x16x32_bf16 v[32:35], v[144:147], a[0:3], v[32:35]
  s_mov_b32 s81, 174080
  ds_read_b128 a[28:31], v27 offset:13120
  ds_write_b64 v31, v[108:109]
  v_mfma_f32_16x16x32_bf16 v[36:39], v[148:151], a[0:3], v[36:39]
  v_mul_f32 v110, 0xc0135761, v108
  v_mfma_f32_16x16x32_bf16 v[44:47], v[148:151], a[4:7], v[44:47]
  s_waitcnt vmcnt(11)
  s_barrier
  ds_read_b128 a[0:3], v26 offset:17408
  v_accvgpr_write_b32 a55, v110
  v_mfma_f32_16x16x32_bf16 v[40:43], v[144:147], a[4:7], v[40:43]
  v_mul_f32_e64 v108, v108, v108
  v_mul_f32 v110, 0x3d372713, v110
  v_mfma_f32_16x16x32_bf16 v[48:51], v[144:147], a[8:11], v[48:51]
  s_mov_b32 s82, 261120
  ds_read_b128 a[4:7], v27 offset:17408
  v_mul_f32_e64 v110, v110, v108
  v_mfma_f32_16x16x32_bf16 v[52:55], v[148:151], a[8:11], v[52:55]
  v_accvgpr_write_b32 a54, v110
  v_mfma_f32_16x16x32_bf16 v[60:63], v[148:151], a[12:15], v[60:63]
  s_waitcnt lgkmcnt(3)
  ds_read_b128 a[8:11], v26 offset:26112
  v_mfma_f32_16x16x32_bf16 v[56:59], v[144:147], a[12:15], v[56:59]
  v_mfma_f32_16x16x32_bf16 v[32:35], v[152:155], a[16:19], v[32:35]
  s_nop 0
  ds_read_b128 a[12:15], v27 offset:26112
  v_mfma_f32_16x16x32_bf16 v[36:39], v[156:159], a[16:19], v[36:39]
  v_mfma_f32_16x16x32_bf16 v[44:47], v[156:159], a[20:23], v[44:47]
  ds_read_b128 a[16:19], v26 offset:17472
  v_mfma_f32_16x16x32_bf16 v[40:43], v[152:155], a[20:23], v[40:43]
  v_mfma_f32_16x16x32_bf16 v[48:51], v[152:155], a[24:27], v[48:51]
  ds_read_b128 a[20:23], v27 offset:17472
  v_mfma_f32_16x16x32_bf16 v[52:55], v[156:159], a[24:27], v[52:55]
  v_mfma_f32_16x16x32_bf16 v[60:63], v[156:159], a[28:31], v[60:63]
  s_waitcnt lgkmcnt(2)
  ds_read_b128 a[24:27], v26 offset:26176
  v_mfma_f32_16x16x32_bf16 v[56:59], v[152:155], a[28:31], v[56:59]
  v_mfma_f32_16x16x32_bf16 v[32:35], v[160:163], a[0:3], v[32:35]
  ds_read_b128 a[28:31], v27 offset:26176
  v_mfma_f32_16x16x32_bf16 v[36:39], v[164:167], a[0:3], v[36:39]
  s_mov_b64 exec, 0
  s_cmp_eq_u32 s4, 0
  s_cbranch_scc1 Lpad3
  s_cmp_eq_u32 s4, 1
  s_cbranch_scc1 Lpad4
Lret3:
Lret4:
  s_mov_b64 exec, -1
  v_mfma_f32_16x16x32_bf16 v[44:47], v[164:167], a[4:7], v[44:47]
  s_lshl_b32 s15, s6, 13
  s_add_u32 s15, s15, 32768
  s_lshl_b32 s3, s5, 9
  s_add_u32 s93, s15, s3
  s_cmp_eq_u32 s4, 0
  s_cselect_b32 s93, s93, 1073741824
  ds_read_b128 a[0:3], v26 offset:21760
  ds_read_b128 a[224:227], v25 offset:17408
  v_mfma_f32_16x16x32_bf16 v[40:43], v[160:163], a[4:7], v[40:43]
  s_lshl_b32 s3, s4, 4
  ds_read_b128 a[228:231], v25 offset:19584
  ds_read_b128 a[232:235], v25 offset:17472
  ds_read_b128 a[236:239], v25 offset:19648
  v_mfma_f32_16x16x32_bf16 v[48:51], v[160:163], a[8:11], v[48:51]
  s_lshr_b64 s[96:97], s[98:99], s3
  s_mul_i32 s13, s4, 12
  s_bfe_u32 s11, s96, 0x30000
  s_sub_u32 s3, s13, s11
  ds_read_b128 a[4:7], v27 offset:21760
  v_mfma_f32_16x16x32_bf16 v[52:55], v[164:167], a[8:11], v[52:55]
  v_mfma_f32_16x16x32_bf16 v[60:63], v[164:167], a[12:15], v[60:63]
  s_add_u32 s3, s3, 0
  s_lshl_b32 s3, s3, 15
  s_add_u32 s38, s3, 32768
  ds_read_b128 a[8:11], v26 offset:30464
  v_mfma_f32_16x16x32_bf16 v[56:59], v[160:163], a[12:15], v[56:59]
  v_mfma_f32_16x16x32_bf16 v[64:67], a[240:243], v[128:131], v[112:115]
  s_waitcnt lgkmcnt(7)
  s_and_b32 s11, s3, 32768
  s_lshl1_add_u32 s34, s11, s3
  s_bfe_u32 s11, s96, 0x30004
  v_mfma_f32_16x16x32_bf16 v[72:75], a[244:247], v[128:131], v[112:115]
  v_mfma_f32_16x16x32_bf16 v[32:35], v[168:171], a[16:19], v[32:35]
  s_sub_u32 s3, s13, s11
  s_add_u32 s3, s3, 3
  s_lshl_b32 s3, s3, 15
  s_add_u32 s39, s3, 32768
  s_nop 0
  ds_read_b128 a[12:15], v27 offset:30464
  v_mfma_f32_16x16x32_bf16 v[36:39], v[172:175], a[16:19], v[36:39]
  v_mfma_f32_16x16x32_bf16 v[44:47], v[172:175], a[20:23], v[44:47]
  s_and_b32 s11, s3, 32768
  s_lshl1_add_u32 s35, s11, s3
  s_bfe_u32 s11, s96, 0x30008
  ds_read_b128 a[16:19], v26 offset:21824
  v_mfma_f32_16x16x32_bf16 v[40:43], v[168:171], a[20:23], v[40:43]
  s_waitcnt lgkmcnt(7)
  v_mfma_f32_16x16x32_bf16 v[120:123], a[248:251], a[224:227], v[120:123]
  s_sub_u32 s3, s13, s11
  s_add_u32 s3, s3, 6
  s_lshl_b32 s3, s3, 15
  s_waitcnt lgkmcnt(6)
  v_mfma_f32_16x16x32_bf16 v[124:127], a[248:251], a[228:231], v[124:127]
  v_mfma_f32_16x16x32_bf16 v[48:51], v[168:171], a[24:27], v[48:51]
  s_add_u32 s40, s3, 32768
  s_and_b32 s11, s3, 32768
  s_lshl1_add_u32 s36, s11, s3
  s_nop 0
  s_bfe_u32 s11, s96, 0x3000c
  ds_read_b128 a[20:23], v27 offset:21824
  v_mfma_f32_16x16x32_bf16 v[52:55], v[172:175], a[24:27], v[52:55]
  v_mfma_f32_16x16x32_bf16 v[60:63], v[172:175], a[28:31], v[60:63]
  s_sub_u32 s3, s13, s11
  s_add_u32 s3, s3, 9
  s_lshl_b32 s3, s3, 15
  ds_read_b128 a[24:27], v26 offset:30528
  v_mfma_f32_16x16x32_bf16 v[56:59], v[168:171], a[28:31], v[56:59]
  s_waitcnt lgkmcnt(7)
  v_mfma_f32_16x16x32_bf16 v[120:123], a[248:251], a[232:235], v[120:123]
  s_add_u32 s41, s3, 32768
  s_and_b32 s11, s3, 32768
  s_lshl1_add_u32 s37, s11, s3
  s_mov_b32 s98, 0x11111111
  s_lshl_b32 s31, s2, 2
  s_add_u32 s31, s31, s4
  s_mul_i32 s31, s31, 1408
  s_waitcnt lgkmcnt(6)
  v_mfma_f32_16x16x32_bf16 v[124:127], a[248:251], a[236:239], v[124:127]
  s_mov_b64 exec, 0x7ff
  buffer_load_dword a36, v29, s[68:71], s31 offen
  s_mov_b64 exec, -1
  v_mfma_f32_16x16x32_bf16 v[68:71], a[240:243], v[136:139], v[112:115]
  s_waitcnt lgkmcnt(3)
  s_mov_b32 s99, 0x555
  s_lshr_b64 s[96:97], s[98:99], s13
  s_mul_i32 s13, s4, 9
  v_mfma_f32_16x16x32_bf16 v[76:79], a[244:247], v[136:139], v[112:115]
  v_mfma_f32_16x16x32_bf16 v[32:35], v[176:179], a[0:3], v[32:35]
  s_movk_i32 s86, 3008
  s_movk_i32 s87, 17216
  s_bfe_u32 s11, s96, 0x30000
  s_lshl1_add_u32 s3, s11, s13
  s_add_u32 s3, s3, 0
  ds_read_b128 a[28:31], v27 offset:30528
  v_mfma_f32_16x16x32_bf16 v[36:39], v[180:183], a[0:3], v[36:39]
  v_mfma_f32_16x16x32_bf16 v[44:47], v[180:183], a[4:7], v[44:47]
  s_waitcnt vmcnt(8)
  s_lshl_b32 s3, s3, 15
  s_andn2_b32 s11, 32768, s3
  s_lshl1_add_u32 s42, s11, s3
  s_bfe_u32 s11, s96, 0x30004
  s_barrier
  ds_read_b128 a[0:3], v26 offset:34816
  v_mfma_f32_16x16x32_bf16 v[40:43], v[176:179], a[4:7], v[40:43]
  v_mfma_f32_16x16x32_bf16 v[48:51], v[176:179], a[8:11], v[48:51]
  s_lshl1_add_u32 s3, s11, s13
  s_add_u32 s3, s3, 3
  s_lshl_b32 s3, s3, 15
  ds_read_b128 a[4:7], v27 offset:34816
  s_nop 0
  v_mfma_f32_16x16x32_bf16 v[52:55], v[180:183], a[8:11], v[52:55]
  v_mfma_f32_16x16x32_bf16 v[60:63], v[180:183], a[12:15], v[60:63]
  s_andn2_b32 s11, 32768, s3
  s_lshl1_add_u32 s43, s11, s3
  s_nop 0
  s_bfe_u32 s11, s96, 0x30008
  ds_read_b128 a[8:11], v26 offset:43520
  v_mfma_f32_16x16x32_bf16 v[56:59], v[176:179], a[12:15], v[56:59]
  v_mfma_f32_16x16x32_bf16 v[80:83], a[240:243], v[132:135], v[116:119]
  v_mfma_f32_16x16x32_bf16 v[88:91], a[244:247], v[132:135], v[116:119]
  s_mov_b64 exec, 0
  s_cmp_eq_u32 s4, 0
  s_cbranch_scc1 Lpad5
  s_cmp_eq_u32 s4, 1
  s_cbranch_scc1 Lpad6
Lret5:
Lret6:
  s_mov_b64 exec, -1
  s_waitcnt lgkmcnt(3)
  v_mfma_f32_16x16x32_bf16 v[32:35], v[184:187], a[16:19], v[32:35]
  s_lshl1_add_u32 s3, s11, s13
  s_add_u32 s3, s3, 6
  s_lshl_b32 s3, s3, 15
  s_andn2_b32 s11, 32768, s3
  s_lshl1_add_u32 s44, s11, s3
  s_cmp_eq_u32 s4, 3
  s_cselect_b32 s44, 1073741824, s44
  s_cselect_b32 s99, 0x33, 0x77
  s_lshr_b32 s3, s12, 1
  ds_read_b128 a[12:15], v27 offset:43520
  v_mfma_f32_16x16x32_bf16 v[36:39], v[188:191], a[16:19], v[36:39]
  v_mfma_f32_16x16x32_bf16 v[44:47], v[188:191], a[20:23], v[44:47]
  s_and_b32 s11, s12, 1
  s_lshr_b32 s13, s3, 2
  s_mul_i32 s101, s13, 2498560
  ds_read_b128 a[16:19], v26 offset:34880
  v_mfma_f32_16x16x32_bf16 v[40:43], v[184:187], a[20:23], v[40:43]
  v_mfma_f32_16x16x32_bf16 v[48:51], v[184:187], a[24:27], v[48:51]
  s_and_b32 s13, s3, 2
  s_lshl_b32 s13, s13, 8
  s_add_u32 s101, s101, s13
  s_add_u32 s101, s101, 1048576
  ds_read_b128 a[20:23], v27 offset:34880
  v_mfma_f32_16x16x32_bf16 v[52:55], v[188:191], a[24:27], v[52:55]
  v_mfma_f32_16x16x32_bf16 v[60:63], v[188:191], a[28:31], v[60:63]
  s_and_b32 s13, s3, 1
  s_lshl_b32 s13, s13, 7
  s_add_u32 s47, s101, s13
  s_lshr_b32 s31, s2, 3
  s_lshl2_add_u32 s31, s31, s4
  ds_read_b128 a[24:27], v26 offset:43584
  v_lshlrev_b32_e64 v30, 6, v1
  v_mfma_f32_16x16x32_bf16 v[56:59], v[184:187], a[28:31], v[56:59]
  s_mul_i32 s31, s31, 11264
  s_mov_b64 exec, 0x7ff
  buffer_load_dword a37, v30, s[68:71], s31 offen offset:384
  s_mov_b64 exec, -1
  v_mfma_f32_16x16x32_bf16 v[84:87], a[240:243], v[140:143], v[116:119]
  s_waitcnt lgkmcnt(3)
  s_and_b32 s13, s7, 1
  s_lshl_b32 s13, s13, 7
  s_add_u32 s101, s101, s13
  v_cvt_pk_bf16_f32 v128, v64, v65
  v_cvt_pk_bf16_f32 v136, v72, v73
  v_mfma_f32_16x16x32_bf16 v[92:95], a[244:247], v[140:143], v[116:119]
  s_lshl_b32 s13, s11, 14
  v_cvt_pk_bf16_f32 v129, v66, v67
  v_cvt_pk_bf16_f32 v137, v74, v75
  v_cvt_pk_bf16_f32 v130, v68, v69
  v_cvt_pk_bf16_f32 v138, v76, v77
  v_cvt_pk_bf16_f32 v131, v70, v71
  v_cvt_pk_bf16_f32 v139, v78, v79
  v_mfma_f32_16x16x32_bf16 v[32:35], v[192:195], a[0:3], v[32:35]
  s_add_u32 s47, s47, s13
  s_lshl_b32 s13, s6, 15
  s_add_u32 s47, s47, s13
  ds_read_b128 a[28:31], v27 offset:43584
  v_mfma_f32_16x16x32_bf16 v[36:39], v[196:199], a[0:3], v[36:39]
  v_mfma_f32_16x16x32_bf16 v[44:47], v[196:199], a[4:7], v[44:47]
  s_add_u32 s14, s47, s13
  s_lshl_b32 s3, s3, 14
  ds_read_b128 a[0:3], v26 offset:39168
  ds_read_b128 a[224:227], v25 offset:34816
  v_mfma_f32_16x16x32_bf16 v[40:43], v[192:195], a[4:7], v[40:43]
  s_lshl_b32 s11, s11, 9
  ds_read_b128 a[228:231], v25 offset:36992
  ds_read_b128 a[232:235], v25 offset:34880
  ds_read_b128 a[236:239], v25 offset:37056
  v_mfma_f32_16x16x32_bf16 v[48:51], v[192:195], a[8:11], v[48:51]
  s_add_u32 s3, s3, s11
  s_add_u32 s3, s3, 262144
  s_lshr_b32 s11, s6, 2
  s_lshl_b32 s11, s11, 12
  ds_read_b128 a[4:7], v27 offset:39168
  v_add_u32 v13, s22, v4
  v_mfma_f32_16x16x32_bf16 v[52:55], v[196:199], a[8:11], v[52:55]
  s_add_u32 m0, s29, 0
  v_mfma_f32_16x16x32_bf16 v[60:63], v[196:199], a[12:15], v[60:63]
  s_and_b32 s13, s6, 3
  s_lshl_b32 s13, s13, 7
  buffer_load_dwordx4 v13, s[56:59], 0 offen lds
  ds_read_b128 a[8:11], v26 offset:47872
  v_mfma_f32_16x16x32_bf16 v[56:59], v[192:195], a[12:15], v[56:59]
  s_add_u32 s95, s3, s11
  buffer_load_dwordx4 v13, s[56:59], s90 offen offset:1024 lds
  v_mfma_f32_16x16x32_bf16 v[64:67], a[240:243], v[144:147], v[112:115]
  s_waitcnt lgkmcnt(7)
  s_add_u32 s95, s95, s13
  s_sub_u32 s12, s6, s94
  s_lshl_b32 s94, s94, 15
  v_mfma_f32_16x16x32_bf16 v[72:75], a[244:247], v[144:147], v[112:115]
  v_mfma_f32_16x16x32_bf16 v[32:35], v[200:203], a[16:19], v[32:35]
  s_sub_u32 s94, s47, s94
  s_mul_i32 s11, s12, 43
  s_lshr_b32 s11, s11, 7
  ds_read_b128 a[12:15], v27 offset:47872
  buffer_load_dwordx4 v13, s[56:59], s91 offen offset:2112 lds
  v_mfma_f32_16x16x32_bf16 v[36:39], v[204:207], a[16:19], v[36:39]
  s_mul_i32 s11, s11, 3712
  v_mfma_f32_16x16x32_bf16 v[44:47], v[204:207], a[20:23], v[44:47]
  s_lshl_b32 s13, s12, 7
  s_add_u32 s96, s3, s11
  s_add_u32 s96, s96, s13
  ds_read_b128 a[16:19], v26 offset:39232
  v_mfma_f32_16x16x32_bf16 v[40:43], v[200:203], a[20:23], v[40:43]
  s_waitcnt lgkmcnt(7)
  v_mfma_f32_16x16x32_bf16 v[120:123], a[248:251], a[224:227], v[120:123]
  s_bitcmp0_b32 0x1e01, s6
  s_cselect_b32 s96, s96, 1073741824
  s_cselect_b32 s94, s94, 1073741824
  s_lshl2_add_u32 s3, s7, s4
  s_lshl_b32 s98, s3, 12
  s_add_u32 s98, s98, 262144
  buffer_load_dwordx4 v13, s[56:59], s92 offen offset:3136 lds
  s_waitcnt lgkmcnt(6)
  v_mfma_f32_16x16x32_bf16 v[124:127], a[248:251], a[228:231], v[124:127]
  v_mfma_f32_16x16x32_bf16 v[48:51], v[200:203], a[24:27], v[48:51]
  ds_read_b128 a[20:23], v27 offset:39232
  v_mfma_f32_16x16x32_bf16 v[52:55], v[204:207], a[24:27], v[52:55]
  v_mfma_f32_16x16x32_bf16 v[60:63], v[204:207], a[28:31], v[60:63]
  ds_read_b128 a[24:27], v26 offset:47936
  v_mfma_f32_16x16x32_bf16 v[56:59], v[200:203], a[28:31], v[56:59]
  s_waitcnt lgkmcnt(7)
  v_mfma_f32_16x16x32_bf16 v[120:123], a[248:251], a[232:235], v[120:123]
  s_add_u32 m0, s29, 16640
  v_add_u32 v13, s23, v4
  s_waitcnt lgkmcnt(6)
  v_mfma_f32_16x16x32_bf16 v[124:127], a[248:251], a[236:239], v[124:127]
  v_mfma_f32_16x16x32_bf16 v[68:71], a[240:243], v[152:155], v[112:115]
  s_waitcnt lgkmcnt(3)
  buffer_load_dwordx4 v13, s[56:59], 0 offen lds
  v_cvt_pk_bf16_f32 v132, v80, v81
  v_mfma_f32_16x16x32_bf16 v[76:79], a[244:247], v[152:155], v[112:115]
  v_cvt_pk_bf16_f32 v140, v88, v89
  v_cvt_pk_bf16_f32 v133, v82, v83
  v_cvt_pk_bf16_f32 v141, v90, v91
  v_cvt_pk_bf16_f32 v134, v84, v85
  v_cvt_pk_bf16_f32 v142, v92, v93
  v_cvt_pk_bf16_f32 v135, v86, v87
  v_cvt_pk_bf16_f32 v143, v94, v95
  v_mfma_f32_16x16x32_bf16 v[32:35], v[208:211], a[0:3], v[32:35]
  ds_read_b128 a[28:31], v27 offset:47936
  buffer_load_dwordx4 v13, s[56:59], s90 offen offset:1024 lds
  v_mfma_f32_16x16x32_bf16 v[36:39], v[212:215], a[0:3], v[36:39]
  v_mfma_f32_16x16x32_bf16 v[44:47], v[212:215], a[4:7], v[44:47]
  s_waitcnt vmcnt(11)
  s_barrier
  ds_read_b128 a[0:3], v26 offset:52224
  v_mfma_f32_16x16x32_bf16 v[40:43], v[208:211], a[4:7], v[40:43]
  v_mfma_f32_16x16x32_bf16 v[48:51], v[208:211], a[8:11], v[48:51]
  ds_read_b128 a[4:7], v27 offset:52224
  v_mfma_f32_16x16x32_bf16 v[52:55], v[212:215], a[8:11], v[52:55]
  v_mfma_f32_16x16x32_bf16 v[60:63], v[212:215], a[12:15], v[60:63]
  ds_read_b128 a[8:11], v26 offset:60928
  buffer_load_dwordx4 v13, s[56:59], s91 offen offset:2112 lds
  v_mfma_f32_16x16x32_bf16 v[56:59], v[208:211], a[12:15], v[56:59]
  v_mfma_f32_16x16x32_bf16 v[80:83], a[240:243], v[148:151], v[116:119]
  s_waitcnt lgkmcnt(3)
  v_mfma_f32_16x16x32_bf16 v[88:91], a[244:247], v[148:151], v[116:119]
  v_mfma_f32_16x16x32_bf16 v[32:35], v[216:219], a[16:19], v[32:35]
  s_nop 0
  ds_read_b128 a[12:15], v27 offset:60928
  buffer_load_dwordx4 v13, s[56:59], s92 offen offset:3136 lds
  v_mfma_f32_16x16x32_bf16 v[36:39], v[220:223], a[16:19], v[36:39]
  v_mfma_f32_16x16x32_bf16 v[44:47], v[220:223], a[20:23], v[44:47]
  ds_read_b128 a[16:19], v26 offset:52288
  v_mfma_f32_16x16x32_bf16 v[40:43], v[216:219], a[20:23], v[40:43]
  v_mfma_f32_16x16x32_bf16 v[48:51], v[216:219], a[24:27], v[48:51]
  ds_read_b128 a[20:23], v27 offset:52288
  v_mfma_f32_16x16x32_bf16 v[52:55], v[220:223], a[24:27], v[52:55]
  v_mfma_f32_16x16x32_bf16 v[60:63], v[220:223], a[28:31], v[60:63]
  s_add_u32 m0, s29, 33280
  ds_read_b128 a[24:27], v26 offset:60992
  v_add_u32 v13, s24, v4
  v_mfma_f32_16x16x32_bf16 v[56:59], v[216:219], a[28:31], v[56:59]
  v_mfma_f32_16x16x32_bf16 v[84:87], a[240:243], v[156:159], v[116:119]
  s_waitcnt lgkmcnt(3)
  buffer_load_dwordx4 v13, s[56:59], 0 offen lds
  buffer_load_dwordx4 v13, s[56:59], s90 offen offset:1024 lds
  v_mfma_f32_16x16x32_bf16 v[92:95], a[244:247], v[156:159], v[116:119]
  v_cvt_pk_bf16_f32 v144, v64, v65
  v_cvt_pk_bf16_f32 v152, v72, v73
  v_cvt_pk_bf16_f32 v145, v66, v67
  v_cvt_pk_bf16_f32 v153, v74, v75
  v_cvt_pk_bf16_f32 v146, v68, v69
  v_cvt_pk_bf16_f32 v154, v76, v77
  v_cvt_pk_bf16_f32 v147, v70, v71
  v_cvt_pk_bf16_f32 v155, v78, v79
  v_mfma_f32_16x16x32_bf16 v[32:35], v[224:227], a[0:3], v[32:35]
  ds_read_b128 a[28:31], v27 offset:60992
  v_mfma_f32_16x16x32_bf16 v[36:39], v[228:231], a[0:3], v[36:39]
  v_mfma_f32_16x16x32_bf16 v[44:47], v[228:231], a[4:7], v[44:47]
  ds_read_b128 a[0:3], v26 offset:56576
  ds_read_b128 a[224:227], v25 offset:52224
  v_mfma_f32_16x16x32_bf16 v[40:43], v[224:227], a[4:7], v[40:43]
  ds_read_b128 a[228:231], v25 offset:54400
  ds_read_b128 a[232:235], v25 offset:52288
  ds_read_b128 a[236:239], v25 offset:54464
  buffer_load_dwordx4 v13, s[56:59], s91 offen offset:2112 lds
  v_mfma_f32_16x16x32_bf16 v[48:51], v[224:227], a[8:11], v[48:51]
  ds_read_b128 a[4:7], v27 offset:56576
  v_mfma_f32_16x16x32_bf16 v[52:55], v[228:231], a[8:11], v[52:55]
  v_mfma_f32_16x16x32_bf16 v[60:63], v[228:231], a[12:15], v[60:63]
  ds_read_b128 a[8:11], v26 offset:65280
  v_mfma_f32_16x16x32_bf16 v[56:59], v[224:227], a[12:15], v[56:59]
  v_mfma_f32_16x16x32_bf16 v[64:67], a[240:243], v[160:163], v[112:115]
  s_waitcnt lgkmcnt(7)
  buffer_load_dwordx4 v13, s[56:59], s92 offen offset:3136 lds
  v_mfma_f32_16x16x32_bf16 v[72:75], a[244:247], v[160:163], v[112:115]
  v_mfma_f32_16x16x32_bf16 v[32:35], v[232:235], a[16:19], v[32:35]
  s_nop 0
  ds_read_b128 a[12:15], v27 offset:65280
  v_mfma_f32_16x16x32_bf16 v[36:39], v[236:239], a[16:19], v[36:39]
  v_mfma_f32_16x16x32_bf16 v[44:47], v[236:239], a[20:23], v[44:47]
  ds_read_b128 a[16:19], v26 offset:56640
  v_mfma_f32_16x16x32_bf16 v[40:43], v[232:235], a[20:23], v[40:43]
  s_waitcnt lgkmcnt(7)
  v_mfma_f32_16x16x32_bf16 v[120:123], a[248:251], a[224:227], v[120:123]
  s_add_u32 m0, s28, 0
  v_mov_b32 v0, v2
  s_waitcnt lgkmcnt(6)
  v_mfma_f32_16x16x32_bf16 v[124:127], a[248:251], a[228:231], v[124:127]
  v_mfma_f32_16x16x32_bf16 v[48:51], v[232:235], a[24:27], v[48:51]
  buffer_load_dwordx4 v0, s[60:63], 0 offen lds
  ds_read_b128 a[20:23], v27 offset:56640
  v_mfma_f32_16x16x32_bf16 v[52:55], v[236:239], a[24:27], v[52:55]
  v_mfma_f32_16x16x32_bf16 v[60:63], v[236:239], a[28:31], v[60:63]
  ds_read_b128 a[24:27], v26 offset:65344
  buffer_load_dwordx4 v0, s[60:63], s83 offen offset:1088 lds
  v_mfma_f32_16x16x32_bf16 v[56:59], v[232:235], a[28:31], v[56:59]
  s_waitcnt lgkmcnt(7)
  v_mfma_f32_16x16x32_bf16 v[120:123], a[248:251], a[232:235], v[120:123]
  s_waitcnt lgkmcnt(6)
  v_mfma_f32_16x16x32_bf16 v[124:127], a[248:251], a[236:239], v[124:127]
  v_mfma_f32_16x16x32_bf16 v[68:71], a[240:243], v[168:171], v[112:115]
  s_waitcnt lgkmcnt(3)
  buffer_load_dwordx4 v0, s[60:63], s84 offen offset:2176 lds
  v_cvt_pk_bf16_f32 v148, v80, v81
  s_nop 0
  v_mfma_f32_16x16x32_bf16 v[76:79], a[244:247], v[168:171], v[112:115]
  v_cvt_pk_bf16_f32 v156, v88, v89
  v_cvt_pk_bf16_f32 v149, v82, v83
  v_cvt_pk_bf16_f32 v157, v90, v91
  v_cvt_pk_bf16_f32 v150, v84, v85
  v_cvt_pk_bf16_f32 v158, v92, v93
  v_cvt_pk_bf16_f32 v151, v86, v87
  v_cvt_pk_bf16_f32 v159, v94, v95
  v_mfma_f32_16x16x32_bf16 v[32:35], v[240:243], a[0:3], v[32:35]
  ds_read_b128 a[28:31], v27 offset:65344
  buffer_load_dwordx4 v0, s[60:63], s85 offen offset:3264 lds
  v_mfma_f32_16x16x32_bf16 v[36:39], v[244:247], a[0:3], v[36:39]
  v_mfma_f32_16x16x32_bf16 v[44:47], v[244:247], a[4:7], v[44:47]
  v_mfma_f32_16x16x32_bf16 v[40:43], v[240:243], a[4:7], v[40:43]
  v_mfma_f32_16x16x32_bf16 v[48:51], v[240:243], a[8:11], v[48:51]
  s_lshl_b32 s0, s4, 7
  v_permlane16_swap_b32 v120, v124
  v_add_u32_e64 v25, s0, v24
  v_mfma_f32_16x16x32_bf16 v[52:55], v[244:247], a[8:11], v[52:55]
  s_add_u32 m0, s28, 17408
  v_add_u32 v0, 32768, v2
  v_mfma_f32_16x16x32_bf16 v[60:63], v[244:247], a[12:15], v[60:63]
  ds_write_b32 v25, v120
  buffer_load_dwordx4 v0, s[60:63], 0 offen lds
  v_mfma_f32_16x16x32_bf16 v[56:59], v[240:243], a[12:15], v[56:59]
  v_mfma_f32_16x16x32_bf16 v[80:83], a[240:243], v[164:167], v[116:119]
  s_waitcnt lgkmcnt(1)
  buffer_load_dwordx4 v0, s[60:63], s83 offen offset:1088 lds
  v_mfma_f32_16x16x32_bf16 v[88:91], a[244:247], v[164:167], v[116:119]
  s_nop 0
  v_mfma_f32_16x16x32_bf16 v[32:35], v[248:251], a[16:19], v[32:35]
  s_waitcnt lgkmcnt(0)
  s_barrier
  ds_read2_b32 v[104:105], v24 offset1:32
  ds_read2_b32 v[106:107], v24 offset0:64 offset1:96
  v_mfma_f32_16x16x32_bf16 v[36:39], v[252:255], a[16:19], v[36:39]
  ds_read_b128 v[96:99], v17
  ds_read_b128 v[100:103], v17 offset:16
  v_mfma_f32_16x16x32_bf16 v[44:47], v[252:255], a[20:23], v[44:47]
  v_mfma_f32_16x16x32_bf16 v[40:43], v[248:251], a[20:23], v[40:43]
  v_mfma_f32_16x16x32_bf16 v[48:51], v[248:251], a[24:27], v[48:51]
  buffer_load_dwordx4 v0, s[60:63], s84 offen offset:2176 lds
  v_mfma_f32_16x16x32_bf16 v[52:55], v[252:255], a[24:27], v[52:55]
  v_mfma_f32_16x16x32_bf16 v[60:63], v[252:255], a[28:31], v[60:63]
  buffer_load_dwordx4 v0, s[60:63], s85 offen offset:3264 lds
  s_waitcnt lgkmcnt(3)
  v_add_f32 v24, v104, v105
  v_mfma_f32_16x16x32_bf16 v[56:59], v[248:251], a[28:31], v[56:59]
  s_waitcnt lgkmcnt(2)
  v_add_f32 v25, v106, v107
  v_mfma_f32_16x16x32_bf16 v[84:87], a[240:243], v[172:175], v[116:119]
  v_cvt_pk_bf16_f32 v160, v64, v65
  v_cvt_pk_bf16_f32 v168, v72, v73
  v_mfma_f32_16x16x32_bf16 v[92:95], a[244:247], v[172:175], v[116:119]
  v_cvt_pk_bf16_f32 v161, v66, v67
  v_cvt_pk_bf16_f32 v169, v74, v75
  v_cvt_pk_bf16_f32 v162, v68, v69
  v_cvt_pk_bf16_f32 v170, v76, v77
  v_cvt_pk_bf16_f32 v163, v70, v71
  v_cvt_pk_bf16_f32 v171, v78, v79
  v_mfma_f32_16x16x32_bf16 v[64:67], a[240:243], v[176:179], v[112:115]
  s_add_u32 m0, s29, 49920
  v_permlane16_swap_b32 v32, v40
  v_permlane16_swap_b32 v48, v56
  v_mfma_f32_16x16x32_bf16 v[72:75], a[244:247], v[176:179], v[112:115]
  v_permlane16_swap_b32 v33, v41
  v_permlane16_swap_b32 v49, v57
  v_permlane16_swap_b32 v34, v42
  v_permlane16_swap_b32 v50, v58
  v_permlane16_swap_b32 v35, v43
  v_permlane16_swap_b32 v51, v59
  v_permlane16_swap_b32 v36, v44
  v_permlane16_swap_b32 v52, v60
  v_permlane16_swap_b32 v37, v45
  v_permlane16_swap_b32 v53, v61
  v_add_u32_e64 v13, s25, v4
  v_mfma_f32_16x16x32_bf16 v[68:71], a[240:243], v[184:187], v[112:115]
  buffer_load_dwordx4 v13, s[56:59], 0 offen lds
  buffer_load_dwordx4 v13, s[56:59], s90 offen offset:1024 lds
  v_mfma_f32_16x16x32_bf16 v[76:79], a[244:247], v[184:187], v[112:115]
  v_cvt_pk_bf16_f32 v164, v80, v81
  v_cvt_pk_bf16_f32 v172, v88, v89
  v_cvt_pk_bf16_f32 v165, v82, v83
  v_cvt_pk_bf16_f32 v173, v90, v91
  v_cvt_pk_bf16_f32 v166, v84, v85
  v_cvt_pk_bf16_f32 v174, v92, v93
  v_cvt_pk_bf16_f32 v167, v86, v87
  v_cvt_pk_bf16_f32 v175, v94, v95
  v_permlane16_swap_b32 v38, v46
  v_permlane16_swap_b32 v54, v62
  v_permlane16_swap_b32 v39, v47
  v_permlane16_swap_b32 v55, v63
  s_waitcnt lgkmcnt(1)
  v_mul_f32 v26, v97, v24
  v_mul_f32 v27, v97, v25
  v_fma_f32 v32, v96, v32, v26
  v_fma_f32 v48, v96, v48, v27
  v_mul_f32 v26, v99, v24
  v_mul_f32_e64 v27, v99, v25
  v_fma_f32 v33, v98, v33, v26
  v_mfma_f32_16x16x32_bf16 v[80:83], a[240:243], v[180:183], v[116:119]
  v_fma_f32 v49, v98, v49, v27
  v_fma_f32 v106, -v15, v48, v33
  v_mfma_f32_16x16x32_bf16 v[88:91], a[244:247], v[180:183], v[116:119]
  v_fma_f32 v107, v15, v32, v49
  v_fmac_f32 v106, v14, v32
  v_fmac_f32 v107, v14, v48
  s_waitcnt lgkmcnt(0)
  v_mul_f32 v26, v101, v24
  v_mul_f32 v27, v101, v25
  v_fma_f32 v34, v100, v34, v26
  v_fma_f32 v50, v100, v50, v27
  v_fma_f32 v104, -v15, v107, v34
  v_mfma_f32_16x16x32_bf16 v[84:87], a[240:243], v[188:191], v[116:119]
  s_waitcnt vmcnt(6)
  ds_read_b128 v[96:99], v17 offset:32
  buffer_load_dwordx4 v13, s[56:59], s91 offen offset:2112 lds
  v_mfma_f32_16x16x32_bf16 v[92:95], a[244:247], v[188:191], v[116:119]
  v_cvt_pk_bf16_f32 v176, v64, v65
  v_cvt_pk_bf16_f32 v184, v72, v73
  v_cvt_pk_bf16_f32 v177, v66, v67
  v_cvt_pk_bf16_f32 v185, v74, v75
  v_cvt_pk_bf16_f32 v178, v68, v69
  v_cvt_pk_bf16_f32 v186, v76, v77
  v_cvt_pk_bf16_f32 v179, v70, v71
  v_cvt_pk_bf16_f32 v187, v78, v79
  v_fma_f32 v105, v15, v106, v50
  v_fmac_f32 v104, v14, v106
  v_fmac_f32 v105, v14, v107
  v_mul_f32 v26, v103, v24
  v_mul_f32 v27, v103, v25
  v_fma_f32 v35, v102, v35, v26
  v_fma_f32 v51, v102, v51, v27
  v_fma_f32 v106, -v15, v105, v35
  v_fma_f32 v107, v15, v104, v51
  v_fmac_f32 v106, v14, v104
  v_fmac_f32 v107, v14, v105
  v_mfma_f32_16x16x32_bf16 v[64:67], a[240:243], v[192:195], v[112:115]
  ds_read_b128 v[100:103], v17 offset:48
  ds_read_b128 a[64:67], v6 offset:0
  v_mfma_f32_16x16x32_bf16 v[72:75], a[244:247], v[192:195], v[112:115]
  ds_read_b128 a[68:71], v6 offset:2176
  buffer_load_dwordx4 v13, s[56:59], s92 offen offset:3136 lds
  ds_read_b128 a[72:75], v6 offset:64
  ds_read_b128 a[76:79], v6 offset:2240
  s_add_u32 m0, s28, 34816
  s_waitcnt lgkmcnt(5)
  v_mul_f32 v26, v97, v24
  v_mul_f32_e64 v27, v97, v25
  v_fma_f32 v36, v96, v36, v26
  v_fma_f32 v52, v96, v52, v27
  v_fma_f32 v104, -v15, v107, v36
  v_fma_f32 v105, v15, v106, v52
  v_fmac_f32 v104, v14, v106
  v_fmac_f32 v105, v14, v107
  v_mul_f32 v26, v99, v24
  v_mul_f32 v27, v99, v25
  v_fma_f32 v37, v98, v37, v26
  v_mov_b32_e64 v0, v2
  v_mfma_f32_16x16x32_bf16 v[68:71], a[240:243], v[200:203], v[112:115]
  buffer_load_dwordx4 v0, s[64:67], 0 offen lds
  buffer_load_dwordx4 v0, s[64:67], s83 offen offset:1088 lds
  v_mfma_f32_16x16x32_bf16 v[76:79], a[244:247], v[200:203], v[112:115]
  v_cvt_pk_bf16_f32 v180, v80, v81
  v_cvt_pk_bf16_f32 v188, v88, v89
  v_cvt_pk_bf16_f32 v181, v82, v83
  v_cvt_pk_bf16_f32 v189, v90, v91
  v_cvt_pk_bf16_f32 v182, v84, v85
Lpad2:
  s_cbranch_execz Lret2
  v_cvt_pk_bf16_f32 v190, v92, v93
  v_cvt_pk_bf16_f32 v183, v86, v87
  v_cvt_pk_bf16_f32 v191, v94, v95
  v_fma_f32 v53, v98, v53, v27
  v_fma_f32 v106, -v15, v105, v37
  v_fma_f32 v107, v15, v104, v53
  v_fmac_f32 v106, v14, v104
  v_fmac_f32 v107, v14, v105
  s_waitcnt lgkmcnt(4)
  v_mul_f32 v26, v101, v24
  v_mul_f32 v27, v101, v25
  v_fma_f32 v38, v100, v38, v26
  v_fma_f32 v54, v100, v54, v27
  v_fma_f32 v104, -v15, v107, v38
  v_mfma_f32_16x16x32_bf16 v[80:83], a[240:243], v[196:199], v[116:119]
  s_waitcnt vmcnt(6)
  ds_read_b128 v[96:99], v17 offset:64
  buffer_load_dwordx4 v0, s[64:67], s84 offen offset:2176 lds
  v_mfma_f32_16x16x32_bf16 v[88:91], a[244:247], v[196:199], v[116:119]
  v_fma_f32 v105, v15, v106, v54
  v_fmac_f32 v104, v14, v106
  v_fmac_f32 v105, v14, v107
  v_mul_f32 v26, v103, v24
  v_mul_f32_e64 v27, v103, v25
  v_fma_f32 v39, v102, v39, v26
  v_fma_f32 v55, v102, v55, v27
  v_fma_f32 v106, -v15, v105, v39
  v_fma_f32 v107, v15, v104, v55
  v_fmac_f32 v106, v14, v104
  v_fmac_f32 v107, v14, v105
  v_mfma_f32_16x16x32_bf16 v[84:87], a[240:243], v[204:207], v[116:119]
  ds_read_b128 v[100:103], v17 offset:80
  ds_read_b128 a[80:83], v6 offset:17408
  v_mfma_f32_16x16x32_bf16 v[92:95], a[244:247], v[204:207], v[116:119]
  ds_read_b128 a[84:87], v6 offset:19584
  buffer_load_dwordx4 v0, s[64:67], s85 offen offset:3264 lds
  ds_read_b128 a[88:91], v6 offset:17472
  ds_read_b128 a[92:95], v6 offset:19648
  s_add_u32 m0, s28, 52224
  v_cvt_pk_bf16_f32 v192, v64, v65
  v_cvt_pk_bf16_f32 v200, v72, v73
  v_cvt_pk_bf16_f32 v193, v66, v67
  v_cvt_pk_bf16_f32 v201, v74, v75
  v_cvt_pk_bf16_f32 v194, v68, v69
  v_cvt_pk_bf16_f32 v202, v76, v77
  v_cvt_pk_bf16_f32 v195, v70, v71
  v_cvt_pk_bf16_f32 v203, v78, v79
  s_waitcnt lgkmcnt(5)
  v_mul_f32 v26, v97, v24
  v_mul_f32_e64 v27, v97, v25
  v_fma_f32 v40, v96, v40, v26
  v_fma_f32 v56, v96, v56, v27
  v_fma_f32 v104, -v15, v107, v40
  v_fma_f32 v105, v15, v106, v56
  v_fmac_f32 v104, v14, v106
  v_fmac_f32 v105, v14, v107
  v_mul_f32 v26, v99, v24
  v_mul_f32 v27, v99, v25
  v_fma_f32 v41, v98, v41, v26
  v_add_u32 v0, 32768, v2
  v_mfma_f32_16x16x32_bf16 v[64:67], a[240:243], v[208:211], v[112:115]
  buffer_load_dwordx4 v0, s[64:67], 0 offen lds
  buffer_load_dwordx4 v0, s[64:67], s83 offen offset:1088 lds
  v_mfma_f32_16x16x32_bf16 v[72:75], a[244:247], v[208:211], v[112:115]
  v_fma_f32 v57, v98, v57, v27
  v_fma_f32 v106, -v15, v105, v41
  v_fma_f32 v107, v15, v104, v57
  v_fmac_f32 v106, v14, v104
  v_fmac_f32 v107, v14, v105
  s_waitcnt lgkmcnt(4)
  v_mul_f32 v26, v101, v24
  v_mul_f32_e64 v27, v101, v25
  v_fma_f32 v42, v100, v42, v26
  v_fma_f32 v58, v100, v58, v27
  v_fma_f32 v104, -v15, v107, v42
  v_mfma_f32_16x16x32_bf16 v[68:71], a[240:243], v[216:219], v[112:115]
  ds_read_b128 v[96:99], v17 offset:96
  v_cvt_pk_bf16_f32 v196, v80, v81
  v_mfma_f32_16x16x32_bf16 v[76:79], a[244:247], v[216:219], v[112:115]
  v_cvt_pk_bf16_f32 v204, v88, v89
  v_cvt_pk_bf16_f32 v197, v82, v83
  v_cvt_pk_bf16_f32 v205, v90, v91
  v_cvt_pk_bf16_f32 v198, v84, v85
  v_cvt_pk_bf16_f32 v206, v92, v93
  v_cvt_pk_bf16_f32 v199, v86, v87
  v_cvt_pk_bf16_f32 v207, v94, v95
  v_fma_f32 v105, v15, v106, v58
  v_fmac_f32 v104, v14, v106
  v_fmac_f32 v105, v14, v107
  v_mul_f32 v26, v103, v24
  v_mul_f32 v27, v103, v25
  v_fma_f32 v43, v102, v43, v26
  v_fma_f32 v59, v102, v59, v27
  v_fma_f32 v106, -v15, v105, v43
  v_fma_f32 v107, v15, v104, v59
  v_fmac_f32 v106, v14, v104
  v_fmac_f32 v107, v14, v105
  v_mfma_f32_16x16x32_bf16 v[80:83], a[240:243], v[212:215], v[116:119]
  ds_read_b128 v[100:103], v17 offset:112
  buffer_load_dwordx4 v0, s[64:67], s84 offen offset:2176 lds
  v_mfma_f32_16x16x32_bf16 v[88:91], a[244:247], v[212:215], v[116:119]
  buffer_load_dwordx4 v0, s[64:67], s85 offen offset:3264 lds
  s_waitcnt lgkmcnt(1)
  v_mul_f32 v26, v97, v24
  v_mul_f32_e64 v27, v97, v25
  v_fma_f32 v44, v96, v44, v26
  v_fma_f32 v60, v96, v60, v27
  v_fma_f32 v104, -v15, v107, v44
  v_fma_f32 v105, v15, v106, v60
  v_fmac_f32_e64 v104, v14, v106
  v_fmac_f32_e64 v105, v14, v107
  v_mul_f32_e64 v26, v99, v24
  v_mul_f32_e64 v27, v99, v25
  v_fma_f32 v45, v98, v45, v26
  v_mfma_f32_16x16x32_bf16 v[84:87], a[240:243], v[220:223], v[116:119]
  v_cvt_pk_bf16_f32 v208, v64, v65
  v_cvt_pk_bf16_f32 v216, v72, v73
  v_mfma_f32_16x16x32_bf16 v[92:95], a[244:247], v[220:223], v[116:119]
  s_add_u32 m0, s28, 0
  v_cvt_pk_bf16_f32 v209, v66, v67
  v_cvt_pk_bf16_f32 v217, v74, v75
  v_cvt_pk_bf16_f32 v210, v68, v69
  s_nop 0
  v_cvt_pk_bf16_f32 v218, v76, v77
  v_cvt_pk_bf16_f32 v211, v70, v71
  v_cvt_pk_bf16_f32 v219, v78, v79
  v_fma_f32 v61, v98, v61, v27
  v_fma_f32 v106, -v15, v105, v45
  v_fma_f32 v107, v15, v104, v61
  v_fmac_f32 v106, v14, v104
  v_fmac_f32_e64 v107, v14, v105
  s_waitcnt lgkmcnt(0)
  v_mul_f32_e64 v26, v101, v24
  v_mul_f32_e64 v27, v101, v25
  v_fma_f32 v46, v100, v46, v26
  v_fma_f32 v62, v100, v62, v27
  v_fma_f32 v104, -v15, v107, v46
  v_fma_f32 v105, v15, v106, v62
  v_add_u32 v0, 128, v2
  v_mfma_f32_16x16x32_bf16 v[64:67], a[240:243], v[224:227], v[112:115]
  buffer_load_dwordx4 v0, s[60:63], 0 offen lds
  buffer_load_dwordx4 v0, s[60:63], s83 offen offset:1088 lds
  v_mfma_f32_16x16x32_bf16 v[72:75], a[244:247], v[224:227], v[112:115]
  v_fmac_f32_e64 v104, v14, v106
  v_fmac_f32_e64 v105, v14, v107
  v_mul_f32_e64 v26, v103, v24
  v_mul_f32_e64 v27, v103, v25
  v_fma_f32 v47, v102, v47, v26
  v_fma_f32 v63, v102, v63, v27
  v_fma_f32 v106, -v15, v105, v47
  v_fma_f32 v107, v15, v104, v63
  v_fmac_f32_e64 v106, v14, v104
  v_fmac_f32 v107, v14, v105
  v_mfma_f32_16x16x32_bf16 v[68:71], a[240:243], v[232:235], v[112:115]
  ds_write_b64 v16, v[106:107]
  s_barrier
  ds_read_b64_tr_b16 a[0:1], v10 offset:0
  v_mfma_f32_16x16x32_bf16 v[76:79], a[244:247], v[232:235], v[112:115]
  ds_read_b64_tr_b16 a[2:3], v10 offset:1024
  buffer_load_dwordx4 v0, s[60:63], s84 offen offset:2176 lds
  v_cvt_pk_bf16_f32 v212, v80, v81
  v_cvt_pk_bf16_f32 v220, v88, v89
  v_cvt_pk_bf16_f32 v213, v82, v83
  v_cvt_pk_bf16_f32 v221, v90, v91
  v_cvt_pk_bf16_f32 v214, v84, v85
  v_cvt_pk_bf16_f32 v222, v92, v93
  v_cvt_pk_bf16_f32 v215, v86, v87
  v_cvt_pk_bf16_f32 v223, v94, v95
  v_mfma_f32_16x16x32_bf16 v[80:83], a[240:243], v[228:231], v[116:119]
  s_waitcnt lgkmcnt(2)
  ds_read_b64_tr_b16 a[4:5], v11 offset:0
  ds_read_b64_tr_b16 a[6:7], v11 offset:1024
  v_mfma_f32_16x16x32_bf16 v[88:91], a[244:247], v[228:231], v[116:119]
  s_barrier
  buffer_load_dwordx4 v0, s[60:63], s85 offen offset:3264 lds
  v_mfma_f32_16x16x32_bf16 v[84:87], a[240:243], v[236:239], v[116:119]
  s_waitcnt vmcnt(8)
  ds_read_b64_tr_b16 a[8:9], v10 offset:8320
  s_nop 0
  ds_read_b64_tr_b16 a[10:11], v10 offset:9344
  v_mfma_f32_16x16x32_bf16 v[92:95], a[244:247], v[236:239], v[116:119]
  s_add_u32 m0, s28, 17408
  ds_read_b128 v[24:27], v23 offset:0
  ds_read_b128 v[28:31], v23 offset:512
  ds_read_b128 a[96:99], v6 offset:34816
  ds_read_b128 a[100:103], v6 offset:36992
  v_cvt_pk_bf16_f32 v224, v64, v65
  v_cvt_pk_bf16_f32 v232, v72, v73
  v_cvt_pk_bf16_f32 v225, v66, v67
  v_cvt_pk_bf16_f32 v233, v74, v75
  v_cvt_pk_bf16_f32 v226, v68, v69
  v_cvt_pk_bf16_f32 v234, v76, v77
  v_cvt_pk_bf16_f32 v227, v70, v71
  v_cvt_pk_bf16_f32 v235, v78, v79
  v_mov_b32 v16, 0
  v_mov_b32 v17, 0
  v_cmp_eq_u32 vcc, 1, v22
  s_waitcnt lgkmcnt(3)
  v_fma_f32 v26, -v19, v25, v26
  v_fmac_f32_e64 v27, v19, v24
  v_add_u32 v0, 32896, v2
  v_mfma_f32_16x16x32_bf16 v[64:67], a[240:243], v[240:243], v[112:115]
  buffer_load_dwordx4 v0, s[60:63], 0 offen lds
  buffer_load_dwordx4 v0, s[60:63], s83 offen offset:1088 lds
  v_mfma_f32_16x16x32_bf16 v[72:75], a[244:247], v[240:243], v[112:115]
  ds_read_b64_tr_b16 a[12:13], v11 offset:8320
  ds_read_b64_tr_b16 a[14:15], v11 offset:9344
  ds_read_b128 a[104:107], v6 offset:34880
  ds_read_b128 a[108:111], v6 offset:37056
  v_cndmask_b32 v16, v16, v24, vcc
  v_cndmask_b32 v17, v17, v25, vcc
  v_fmac_f32 v26, v18, v24
  v_fmac_f32 v27, v18, v25
  v_cmp_eq_u32 vcc, 2, v22
  s_waitcnt lgkmcnt(6)
  v_fma_f32 v28, -v19, v27, v28
  v_fmac_f32_e64 v29, v19, v26
  v_mfma_f32_16x16x32_bf16 v[68:71], a[240:243], v[248:251], v[112:115]
  ds_read_b64_tr_b16 a[16:17], v10 offset:64
  ds_read_b64_tr_b16 a[18:19], v10 offset:1088
  v_mfma_f32_16x16x32_bf16 v[76:79], a[244:247], v[248:251], v[112:115]
  v_cvt_pk_bf16_f32 v228, v80, v81
  v_cvt_pk_bf16_f32 v236, v88, v89
  v_cvt_pk_bf16_f32 v229, v82, v83
  v_cvt_pk_bf16_f32 v237, v90, v91
  v_cvt_pk_bf16_f32 v230, v84, v85
  v_cvt_pk_bf16_f32 v238, v92, v93
  v_cvt_pk_bf16_f32 v231, v86, v87
  v_cvt_pk_bf16_f32 v239, v94, v95
  v_cndmask_b32 v16, v16, v26, vcc
  v_cndmask_b32 v17, v17, v27, vcc
  v_fmac_f32_e64 v28, v18, v26
  v_fmac_f32_e64 v29, v18, v27
  v_cmp_eq_u32 vcc, 3, v22
  v_fma_f32 v30, -v19, v29, v30
  v_mfma_f32_16x16x32_bf16 v[80:83], a[240:243], v[244:247], v[116:119]
  s_waitcnt vmcnt(6) lgkmcnt(2)
  ds_read_b128 v[24:27], v23 offset:1024
  buffer_load_dwordx4 v0, s[60:63], s84 offen offset:2176 lds
  v_mfma_f32_16x16x32_bf16 v[88:91], a[244:247], v[244:247], v[116:119]
  buffer_load_dwordx4 v0, s[60:63], s85 offen offset:3264 lds
  ds_read_b64_tr_b16 a[20:21], v11 offset:64
  ds_read_b64_tr_b16 a[22:23], v11 offset:1088
  ds_read_b128 a[112:115], v6 offset:52224
  ds_read_b128 a[116:119], v6 offset:54400
  s_add_u32 m0, s28, 34816
  v_fmac_f32 v31, v19, v28
  v_cndmask_b32 v16, v16, v28, vcc
  v_cndmask_b32 v17, v17, v29, vcc
  v_fmac_f32 v30, v18, v28
  v_fmac_f32_e64 v31, v18, v29
  v_cmp_eq_u32 vcc, 4, v22
  s_waitcnt lgkmcnt(4)
  v_fma_f32 v24, -v19, v31, v24
  v_add_u32 v0, 128, v2
  v_mfma_f32_16x16x32_bf16 v[84:87], a[240:243], v[252:255], v[116:119]
  buffer_load_dwordx4 v0, s[64:67], 0 offen lds
  ds_read_b64_tr_b16 a[24:25], v10 offset:8384
  v_mfma_f32_16x16x32_bf16 v[92:95], a[244:247], v[252:255], v[116:119]
  ds_read_b64_tr_b16 a[26:27], v10 offset:9408
  v_cvt_pk_bf16_f32 v240, v64, v65
  v_cvt_pk_bf16_f32 v248, v72, v73
  v_cvt_pk_bf16_f32 v241, v66, v67
  v_cvt_pk_bf16_f32 v249, v74, v75
  v_cvt_pk_bf16_f32 v242, v68, v69
  v_cvt_pk_bf16_f32 v250, v76, v77
  v_cvt_pk_bf16_f32 v243, v70, v71
  v_cvt_pk_bf16_f32 v251, v78, v79
  v_fmac_f32 v25, v19, v30
  v_cndmask_b32 v16, v16, v30, vcc
  v_cndmask_b32 v17, v17, v31, vcc
  v_fmac_f32 v24, v18, v30
  v_fmac_f32_e64 v25, v18, v31
  v_mfma_f32_16x16x32_bf16 v[64:67], a[0:3], v[128:131], 0
  ds_read_b128 v[28:31], v23 offset:1536
  ds_read_b128 a[120:123], v6 offset:52288
  v_mfma_f32_16x16x32_bf16 v[72:75], a[0:3], v[132:135], 0
  ds_read_b128 a[124:127], v6 offset:54464
  buffer_load_dwordx4 v0, s[64:67], s83 offen offset:1088 lds
  ds_read_b64_tr_b16 a[28:29], v11 offset:8384
  ds_read_b64_tr_b16 a[30:31], v11 offset:9408
  buffer_load_dwordx4 v0, s[64:67], s84 offen offset:2176 lds
  buffer_load_dwordx4 v0, s[64:67], s85 offen offset:3264 lds
  v_cvt_pk_bf16_f32 v244, v80, v81
  v_cvt_pk_bf16_f32 v252, v88, v89
  v_cvt_pk_bf16_f32 v245, v82, v83
  v_cvt_pk_bf16_f32 v253, v90, v91
  v_cvt_pk_bf16_f32 v246, v84, v85
  v_cvt_pk_bf16_f32 v254, v92, v93
  v_cvt_pk_bf16_f32 v247, v86, v87
  v_cvt_pk_bf16_f32 v255, v94, v95
  v_cmp_eq_u32 vcc, 5, v22
  v_fma_f32 v26, -v19, v25, v26
  v_fmac_f32 v27, v19, v24
  v_cndmask_b32 v16, v16, v24, vcc
  v_cndmask_b32 v17, v17, v25, vcc
  v_fmac_f32 v26, v18, v24
  v_fmac_f32 v27, v18, v25
  v_mfma_f32_16x16x32_bf16 v[76:79], a[4:7], v[132:135], 0
  ds_read_b64_tr_b16 a[0:1], v10 offset:4160
  ds_read_b64_tr_b16 a[2:3], v10 offset:5184
  v_mfma_f32_16x16x32_bf16 v[68:71], a[4:7], v[128:131], 0
  v_cmp_eq_u32 vcc, 6, v22
  s_waitcnt lgkmcnt(6)
  v_fma_f32 v28, -v19, v27, v28
  v_fmac_f32 v29, v19, v26
  v_cndmask_b32 v16, v16, v26, vcc
  v_cndmask_b32 v17, v17, v27, vcc
  v_fmac_f32 v28, v18, v26
  v_fmac_f32 v29, v18, v27
  v_mfma_f32_16x16x32_bf16 v[80:83], a[8:11], v[128:131], 0
  s_waitcnt vmcnt(8) lgkmcnt(4)
  ds_read_b64_tr_b16 a[4:5], v11 offset:4160
  ds_read_b64_tr_b16 a[6:7], v11 offset:5184
  v_mfma_f32_16x16x32_bf16 v[88:91], a[8:11], v[132:135], 0
  s_add_u32 m0, s28, 52224
  ds_read_b128 a[128:131], v6 offset:0
  ds_read_b128 a[132:135], v6 offset:2176
  v_cmp_eq_u32 vcc, 7, v22
  v_fma_f32 v30, -v19, v29, v30
  v_fmac_f32 v31, v19, v28
  v_cndmask_b32 v16, v16, v28, vcc
  v_cndmask_b32 v17, v17, v29, vcc
  v_fmac_f32_e64 v30, v18, v28
  v_fmac_f32 v31, v18, v29
  v_add_u32 v0, 32896, v2
  v_mfma_f32_16x16x32_bf16 v[92:95], a[12:15], v[132:135], 0
  s_waitcnt lgkmcnt(6)
  buffer_load_dwordx4 v0, s[64:67], 0 offen lds
  buffer_load_dwordx4 v0, s[64:67], s83 offen offset:1088 lds
  v_mfma_f32_16x16x32_bf16 v[84:87], a[12:15], v[128:131], 0
  ds_read_b64_tr_b16 a[8:9], v10 offset:12480
  ds_read_b64_tr_b16 a[10:11], v10 offset:13504
  v_mov_b32 v28, s10
  v_mov_b32 v29, s10
  s_mov_b32 exec_hi, 0
  buffer_store_dwordx4 v[28:31], v1, s[72:75], s93 offen sc1
  s_mov_b32 exec_hi, -1
  v_mfma_f32_16x16x32_bf16 v[96:99], a[16:19], v[128:131], 0
  ds_read_b128 a[136:139], v6 offset:64
  ds_read_b128 a[140:143], v6 offset:2240
  v_mfma_f32_16x16x32_bf16 v[104:107], a[16:19], v[132:135], 0
  ds_read_b64_tr_b16 a[12:13], v11 offset:12480
  ds_read_b64_tr_b16 a[14:15], v11 offset:13504
  v_mul_f32 v18, v17, v21
  v_mul_f32 v19, v16, v21
  v_mfma_f32_16x16x32_bf16 v[108:111], a[20:23], v[132:135], 0
  ds_read_b64_tr_b16 a[16:17], v10 offset:4224
  ds_read_b64_tr_b16 a[18:19], v10 offset:5248
  v_mfma_f32_16x16x32_bf16 v[100:103], a[20:23], v[128:131], 0
  v_fma_f32 v16, v16, v20, -v18
  v_fma_f32 v17, v17, v20, v19
  v_mfma_f32_16x16x32_bf16 v[112:115], a[24:27], v[128:131], 0
  ds_read_b64_tr_b16 a[20:21], v11 offset:4224
  ds_read_b64_tr_b16 a[22:23], v11 offset:5248
  v_mfma_f32_16x16x32_bf16 v[120:123], a[24:27], v[132:135], 0
  v_mul_f32 v18, v48, v21
  v_mul_f32_e64 v19, v32, v21
  v_mfma_f32_16x16x32_bf16 v[124:127], a[28:31], v[132:135], 0
  s_waitcnt lgkmcnt(4)
  ds_read_b64_tr_b16 a[24:25], v10 offset:12544
  ds_read_b64_tr_b16 a[26:27], v10 offset:13568
  v_mfma_f32_16x16x32_bf16 v[116:119], a[28:31], v[128:131], 0
  v_fma_f32 v32, v32, v20, -v18
  v_fma_f32 v48, v48, v20, v19
  v_mfma_f32_16x16x32_bf16 v[64:67], a[0:3], v[144:147], v[64:67]
  s_waitcnt vmcnt(7)
  ds_read_b64_tr_b16 a[28:29], v11 offset:12544
  ds_read_b64_tr_b16 a[30:31], v11 offset:13568
  s_nop 0
  v_mfma_f32_16x16x32_bf16 v[72:75], a[0:3], v[148:151], v[72:75]
  ds_read_b128 a[144:147], v6 offset:17408
  ds_read_b128 a[148:151], v6 offset:19584
  buffer_load_dwordx4 v0, s[64:67], s84 offen offset:2176 lds
  v_mul_f32 v18, v49, v21
  v_mul_f32_e64 v19, v33, v21
  v_mfma_f32_16x16x32_bf16 v[76:79], a[4:7], v[148:151], v[76:79]
  s_barrier
  ds_read_b64_tr_b16 a[0:1], v10 offset:16640
  ds_read_b64_tr_b16 a[2:3], v10 offset:17664
  v_mfma_f32_16x16x32_bf16 v[68:71], a[4:7], v[144:147], v[68:71]
  ds_read_b128 a[152:155], v6 offset:17472
  ds_read_b128 a[156:159], v6 offset:19648
  v_fma_f32 v33, v33, v20, -v18
  v_fma_f32 v49, v49, v20, v19
  v_mfma_f32_16x16x32_bf16 v[80:83], a[8:11], v[144:147], v[80:83]
  ds_read_b64_tr_b16 a[4:5], v11 offset:16640
  ds_read_b64_tr_b16 a[6:7], v11 offset:17664
  v_mfma_f32_16x16x32_bf16 v[88:91], a[8:11], v[148:151], v[88:91]
  buffer_load_dwordx4 v0, s[64:67], s85 offen offset:3264 lds
  v_mul_f32_e64 v18, v50, v21
  v_mul_f32 v19, v34, v21
  v_mfma_f32_16x16x32_bf16 v[92:95], a[12:15], v[148:151], v[92:95]
  s_waitcnt lgkmcnt(8)
  ds_read_b64_tr_b16 a[8:9], v10 offset:24960
  ds_read_b64_tr_b16 a[10:11], v10 offset:25984
  v_mfma_f32_16x16x32_bf16 v[84:87], a[12:15], v[144:147], v[84:87]
  v_fma_f32 v34, v34, v20, -v18
  v_fma_f32 v50, v50, v20, v19
  v_mfma_f32_16x16x32_bf16 v[96:99], a[16:19], v[144:147], v[96:99]
  s_add_u32 m0, s29, 0
  ds_read_b64_tr_b16 a[12:13], v11 offset:24960
  ds_read_b64_tr_b16 a[14:15], v11 offset:25984
  v_mfma_f32_16x16x32_bf16 v[104:107], a[16:19], v[148:151], v[104:107]
  v_mul_f32 v18, v51, v21
  v_mul_f32_e64 v19, v35, v21
  v_add_u32_e64 v13, s26, v5
  v_mfma_f32_16x16x32_bf16 v[108:111], a[20:23], v[148:151], v[108:111]
  buffer_load_dwordx4 v13, s[56:59], 0 offen lds
  ds_read_b64_tr_b16 a[16:17], v10 offset:16704
  v_mfma_f32_16x16x32_bf16 v[100:103], a[20:23], v[144:147], v[100:103]
  ds_read_b64_tr_b16 a[18:19], v10 offset:17728
  v_fma_f32 v35, v35, v20, -v18
  v_fma_f32 v51, v51, v20, v19
  v_mfma_f32_16x16x32_bf16 v[112:115], a[24:27], v[144:147], v[112:115]
  ds_read_b64_tr_b16 a[20:21], v11 offset:16704
  ds_read_b64_tr_b16 a[22:23], v11 offset:17728
  v_mfma_f32_16x16x32_bf16 v[120:123], a[24:27], v[148:151], v[120:123]
  v_mul_f32_e64 v18, v52, v21
  v_mul_f32_e64 v19, v36, v21
  v_mfma_f32_16x16x32_bf16 v[124:127], a[28:31], v[148:151], v[124:127]
  s_waitcnt lgkmcnt(4)
  ds_read_b64_tr_b16 a[24:25], v10 offset:25024
  ds_read_b64_tr_b16 a[26:27], v10 offset:26048
  v_mfma_f32_16x16x32_bf16 v[116:119], a[28:31], v[144:147], v[116:119]
  v_fma_f32 v36, v36, v20, -v18
  v_fma_f32 v52, v52, v20, v19
  v_mfma_f32_16x16x32_bf16 v[64:67], a[0:3], v[160:163], v[64:67]
  s_waitcnt vmcnt(6)
  ds_read_b64_tr_b16 a[28:29], v11 offset:25024
  ds_read_b64_tr_b16 a[30:31], v11 offset:26048
  v_mfma_f32_16x16x32_bf16 v[72:75], a[0:3], v[164:167], v[72:75]
  ds_read_b128 a[160:163], v6 offset:34816
  ds_read_b128 a[164:167], v6 offset:36992
  buffer_load_dwordx4 v13, s[56:59], s80 offen offset:1024 lds
  v_mul_f32_e64 v18, v53, v21
  v_mul_f32_e64 v19, v37, v21
  v_mfma_f32_16x16x32_bf16 v[76:79], a[4:7], v[164:167], v[76:79]
  ds_read_b64_tr_b16 a[0:1], v10 offset:20800
  ds_read_b64_tr_b16 a[2:3], v10 offset:21824
  v_mfma_f32_16x16x32_bf16 v[68:71], a[4:7], v[160:163], v[68:71]
  ds_read_b128 a[168:171], v6 offset:34880
  ds_read_b128 a[172:175], v6 offset:37056
  v_fma_f32 v37, v37, v20, -v18
  v_fma_f32 v53, v53, v20, v19
  v_mfma_f32_16x16x32_bf16 v[80:83], a[8:11], v[160:163], v[80:83]
  ds_read_b64_tr_b16 a[4:5], v11 offset:20800
  ds_read_b64_tr_b16 a[6:7], v11 offset:21824
  v_mfma_f32_16x16x32_bf16 v[88:91], a[8:11], v[164:167], v[88:91]
  v_mul_f32_e64 v18, v54, v21
  v_mul_f32 v19, v38, v21
  v_mfma_f32_16x16x32_bf16 v[92:95], a[12:15], v[164:167], v[92:95]
  s_waitcnt lgkmcnt(8)
  ds_read_b64_tr_b16 a[8:9], v10 offset:29120
  ds_read_b64_tr_b16 a[10:11], v10 offset:30144
  v_mfma_f32_16x16x32_bf16 v[84:87], a[12:15], v[160:163], v[84:87]
  buffer_load_dwordx4 v13, s[56:59], s81 offen offset:2048 lds
  v_fma_f32 v38, v38, v20, -v18
  v_fma_f32 v54, v54, v20, v19
  v_mfma_f32_16x16x32_bf16 v[96:99], a[16:19], v[160:163], v[96:99]
  ds_read_b64_tr_b16 a[12:13], v11 offset:29120
  ds_read_b64_tr_b16 a[14:15], v11 offset:30144
  v_mfma_f32_16x16x32_bf16 v[104:107], a[16:19], v[164:167], v[104:107]
  v_mul_f32_e64 v18, v55, v21
  v_mul_f32_e64 v19, v39, v21
  v_mfma_f32_16x16x32_bf16 v[108:111], a[20:23], v[164:167], v[108:111]
  ds_read_b64_tr_b16 a[16:17], v10 offset:20864
  ds_read_b64_tr_b16 a[18:19], v10 offset:21888
  v_mfma_f32_16x16x32_bf16 v[100:103], a[20:23], v[160:163], v[100:103]
  v_fma_f32 v39, v39, v20, -v18
  v_fma_f32 v55, v55, v20, v19
  v_mfma_f32_16x16x32_bf16 v[112:115], a[24:27], v[160:163], v[112:115]
  ds_read_b64_tr_b16 a[20:21], v11 offset:20864
  ds_read_b64_tr_b16 a[22:23], v11 offset:21888
  v_mfma_f32_16x16x32_bf16 v[120:123], a[24:27], v[164:167], v[120:123]
  v_mul_f32 v18, v56, v21
  v_mfma_f32_16x16x32_bf16 v[124:127], a[28:31], v[164:167], v[124:127]
  s_waitcnt lgkmcnt(4)
  ds_read_b64_tr_b16 a[24:25], v10 offset:29184
  ds_read_b64_tr_b16 a[26:27], v10 offset:30208
  v_mfma_f32_16x16x32_bf16 v[116:119], a[28:31], v[160:163], v[116:119]
  buffer_load_dwordx4 v13, s[56:59], s82 offen offset:3072 lds
  v_mul_f32_e64 v19, v40, v21
  v_fma_f32 v40, v40, v20, -v18
  v_mfma_f32_16x16x32_bf16 v[64:67], a[0:3], v[176:179], v[64:67]
  ds_read_b64_tr_b16 a[28:29], v11 offset:29184
  ds_read_b64_tr_b16 a[30:31], v11 offset:30208
  v_mfma_f32_16x16x32_bf16 v[72:75], a[0:3], v[180:183], v[72:75]
  v_fma_f32 v56, v56, v20, v19
  v_mul_f32 v18, v57, v21
  v_mfma_f32_16x16x32_bf16 v[76:79], a[4:7], v[180:183], v[76:79]
  s_barrier
  ds_read_b64_tr_b16 a[0:1], v10 offset:33280
  ds_read_b64_tr_b16 a[2:3], v10 offset:34304
  v_mfma_f32_16x16x32_bf16 v[68:71], a[4:7], v[176:179], v[68:71]
  v_mul_f32_e64 v19, v41, v21
  v_fma_f32 v41, v41, v20, -v18
  v_mfma_f32_16x16x32_bf16 v[80:83], a[8:11], v[176:179], v[80:83]
  ds_read_b64_tr_b16 a[4:5], v11 offset:33280
  ds_read_b64_tr_b16 a[6:7], v11 offset:34304
  v_mfma_f32_16x16x32_bf16 v[88:91], a[8:11], v[180:183], v[88:91]
  v_fma_f32 v57, v57, v20, v19
  v_mul_f32 v18, v58, v21
  v_mfma_f32_16x16x32_bf16 v[92:95], a[12:15], v[180:183], v[92:95]
  s_waitcnt lgkmcnt(4)
  ds_read_b64_tr_b16 a[8:9], v10 offset:41600
  ds_read_b64_tr_b16 a[10:11], v10 offset:42624
  v_mfma_f32_16x16x32_bf16 v[84:87], a[12:15], v[176:179], v[84:87]
  s_add_u32 m0, s28, 0
  v_mul_f32 v19, v42, v21
  v_fma_f32 v42, v42, v20, -v18
  v_add_u32_e64 v0, s34, v3
  v_mfma_f32_16x16x32_bf16 v[96:99], a[16:19], v[176:179], v[96:99]
  buffer_load_dwordx4 v0, s[68:71], 0 offen lds
  ds_read_b64_tr_b16 a[12:13], v11 offset:41600
  v_mfma_f32_16x16x32_bf16 v[104:107], a[16:19], v[180:183], v[104:107]
  ds_read_b64_tr_b16 a[14:15], v11 offset:42624
  buffer_load_dwordx4 v0, s[68:71], s86 offen offset:1088 lds
  v_fma_f32 v58, v58, v20, v19
  v_mul_f32 v18, v59, v21
  v_mfma_f32_16x16x32_bf16 v[108:111], a[20:23], v[180:183], v[108:111]
  s_waitcnt vmcnt(6)
  ds_read_b64_tr_b16 a[16:17], v10 offset:33344
  ds_read_b64_tr_b16 a[18:19], v10 offset:34368
  v_mfma_f32_16x16x32_bf16 v[100:103], a[20:23], v[176:179], v[100:103]
  ds_read_b128 a[176:179], v6 offset:52224
  ds_read_b128 a[180:183], v6 offset:54400
  v_mul_f32_e64 v19, v43, v21
  v_fma_f32 v43, v43, v20, -v18
  v_mfma_f32_16x16x32_bf16 v[112:115], a[24:27], v[176:179], v[112:115]
  ds_read_b64_tr_b16 a[20:21], v11 offset:33344
  ds_read_b64_tr_b16 a[22:23], v11 offset:34368
  v_mfma_f32_16x16x32_bf16 v[120:123], a[24:27], v[180:183], v[120:123]
  ds_read_b128 a[184:187], v6 offset:52288
  ds_read_b128 a[188:191], v6 offset:54464
  v_fma_f32 v59, v59, v20, v19
  v_mul_f32 v18, v60, v21
  v_accvgpr_read_b32 v24, a46
  v_accvgpr_read_b32 v28, a47
  v_mfma_f32_16x16x32_bf16 v[124:127], a[28:31], v[180:183], v[124:127]
  s_waitcnt lgkmcnt(8)
  buffer_load_dwordx4 v[24:27], v24, s[72:75], s15 offen sc1
  buffer_load_dwordx4 v[28:31], v28, s[72:75], s15 offen sc1
  v_mfma_f32_16x16x32_bf16 v[116:119], a[28:31], v[176:179], v[116:119]
  s_add_u32 m0, s29, 16640
  ds_read_b64_tr_b16 a[24:25], v10 offset:41664
  ds_read_b64_tr_b16 a[26:27], v10 offset:42688
  v_mul_f32 v19, v44, v21
  v_fma_f32 v44, v44, v20, -v18
  v_add_u32 v13, s27, v5
  v_mfma_f32_16x16x32_bf16 v[64:67], a[0:3], v[192:195], v[64:67]
  buffer_load_dwordx4 v13, s[56:59], 0 offen lds
  ds_read_b64_tr_b16 a[28:29], v11 offset:41664
  v_mfma_f32_16x16x32_bf16 v[72:75], a[0:3], v[196:199], v[72:75]
  ds_read_b64_tr_b16 a[30:31], v11 offset:42688
  v_fma_f32 v60, v60, v20, v19
  v_mul_f32_e64 v18, v61, v21
  v_mfma_f32_16x16x32_bf16 v[76:79], a[4:7], v[196:199], v[76:79]
  ds_read_b64_tr_b16 a[0:1], v10 offset:37440
  ds_read_b64_tr_b16 a[2:3], v10 offset:38464
  v_mfma_f32_16x16x32_bf16 v[68:71], a[4:7], v[192:195], v[68:71]
  v_mul_f32_e64 v19, v45, v21
  v_fma_f32 v45, v45, v20, -v18
  v_mfma_f32_16x16x32_bf16 v[80:83], a[8:11], v[192:195], v[80:83]
  ds_read_b64_tr_b16 a[4:5], v11 offset:37440
  ds_read_b64_tr_b16 a[6:7], v11 offset:38464
  v_mfma_f32_16x16x32_bf16 v[88:91], a[8:11], v[196:199], v[88:91]
  v_fma_f32 v61, v61, v20, v19
  v_mul_f32 v18, v62, v21
  v_mfma_f32_16x16x32_bf16 v[92:95], a[12:15], v[196:199], v[92:95]
  s_waitcnt lgkmcnt(4)
  ds_read_b64_tr_b16 a[8:9], v10 offset:45760
  ds_read_b64_tr_b16 a[10:11], v10 offset:46784
  v_mfma_f32_16x16x32_bf16 v[84:87], a[12:15], v[192:195], v[84:87]
Lpad3:
  s_cbranch_execz Lret3
  s_nop 0
  buffer_load_dwordx4 v13, s[56:59], s80 offen offset:1024 lds
  v_mul_f32_e64 v19, v46, v21
  v_fma_f32 v46, v46, v20, -v18
  v_mfma_f32_16x16x32_bf16 v[96:99], a[16:19], v[192:195], v[96:99]
  ds_read_b64_tr_b16 a[12:13], v11 offset:45760
  ds_read_b64_tr_b16 a[14:15], v11 offset:46784
  v_mfma_f32_16x16x32_bf16 v[104:107], a[16:19], v[196:199], v[104:107]
  v_fma_f32 v62, v62, v20, v19
  v_mul_f32_e64 v18, v63, v21
  v_mfma_f32_16x16x32_bf16 v[108:111], a[20:23], v[196:199], v[108:111]
  ds_read_b64_tr_b16 a[16:17], v10 offset:37504
  ds_read_b64_tr_b16 a[18:19], v10 offset:38528
  v_mfma_f32_16x16x32_bf16 v[100:103], a[20:23], v[192:195], v[100:103]
  v_mul_f32_e64 v19, v47, v21
  v_fma_f32 v47, v47, v20, -v18
  v_mfma_f32_16x16x32_bf16 v[112:115], a[24:27], v[192:195], v[112:115]
  ds_read_b64_tr_b16 a[20:21], v11 offset:37504
  ds_read_b64_tr_b16 a[22:23], v11 offset:38528
  v_mfma_f32_16x16x32_bf16 v[120:123], a[24:27], v[196:199], v[120:123]
  buffer_load_dwordx4 v13, s[56:59], s81 offen offset:2048 lds
  v_fma_f32 v63, v63, v20, v19
  v_accvgpr_read_b32 v18, a42
  v_mfma_f32_16x16x32_bf16 v[124:127], a[28:31], v[196:199], v[124:127]
  s_waitcnt lgkmcnt(4)
  ds_read_b64_tr_b16 a[24:25], v10 offset:45824
  s_nop 0
  ds_read_b64_tr_b16 a[26:27], v10 offset:46848
  v_mfma_f32_16x16x32_bf16 v[116:119], a[28:31], v[192:195], v[116:119]
  v_accvgpr_read_b32 v19, a43
  v_accvgpr_read_b32 v20, a44
  v_mfma_f32_16x16x32_bf16 v[64:67], a[0:3], v[208:211], v[64:67]
  ds_read_b64_tr_b16 a[28:29], v11 offset:45824
  ds_read_b64_tr_b16 a[30:31], v11 offset:46848
  v_mfma_f32_16x16x32_bf16 v[72:75], a[0:3], v[212:215], v[72:75]
  v_accvgpr_read_b32 v21, a45
  v_mfma_f32_16x16x32_bf16 v[76:79], a[4:7], v[212:215], v[76:79]
  s_barrier
  ds_read_b64_tr_b16 a[0:1], v10 offset:49920
  ds_read_b64_tr_b16 a[2:3], v10 offset:50944
  v_mfma_f32_16x16x32_bf16 v[68:71], a[4:7], v[208:211], v[68:71]
  v_mfma_f32_16x16x32_bf16 v[80:83], a[8:11], v[208:211], v[80:83]
  ds_read_b64_tr_b16 a[4:5], v11 offset:49920
  ds_read_b64_tr_b16 a[6:7], v11 offset:50944
  v_mfma_f32_16x16x32_bf16 v[88:91], a[8:11], v[212:215], v[88:91]
  v_mfma_f32_16x16x32_bf16 v[92:95], a[12:15], v[212:215], v[92:95]
  s_waitcnt lgkmcnt(4)
  ds_read_b64_tr_b16 a[8:9], v10 offset:58240
  ds_read_b64_tr_b16 a[10:11], v10 offset:59264
  v_mfma_f32_16x16x32_bf16 v[84:87], a[12:15], v[208:211], v[84:87]
  buffer_load_dwordx4 v13, s[56:59], s82 offen offset:3072 lds
  v_mfma_f32_16x16x32_bf16 v[96:99], a[16:19], v[208:211], v[96:99]
  ds_read_b64_tr_b16 a[12:13], v11 offset:58240
  ds_read_b64_tr_b16 a[14:15], v11 offset:59264
  v_mfma_f32_16x16x32_bf16 v[104:107], a[16:19], v[212:215], v[104:107]
  v_mfma_f32_16x16x32_bf16 v[108:111], a[20:23], v[212:215], v[108:111]
  s_waitcnt vmcnt(4)
  ds_read_b64_tr_b16 a[16:17], v10 offset:49984
  ds_read_b64_tr_b16 a[18:19], v10 offset:51008
  v_mfma_f32_16x16x32_bf16 v[100:103], a[20:23], v[208:211], v[100:103]
  v_xor_b32 v24, s10, v24
  v_xor_b32 v28, s10, v28
  v_xor_b32 v25, s10, v25
  v_xor_b32 v29, s10, v29
  v_or_b32 v24, v24, v25
  v_or_b32_e64 v28, v28, v29
  v_cmp_ne_u32 s[0:1], 0, v24
  v_cmp_ne_u32 vcc, 0, v28
  s_and_b64 s[0:1], s[0:1], s[20:21]
  s_and_b64 vcc, vcc, s[18:19]
  s_or_b64 s[0:1], s[0:1], vcc
  s_cbranch_scc1 Le_slow
Le_back:
  v_mul_f32 v24, v26, v18
  v_mul_f32_e64 v25, v26, v19
  v_fma_f32 v24, -v27, v19, v24
  v_fmac_f32_e64 v25, v27, v18
  v_lshlrev_b32_e64 v13, 24, v1
  v_and_b32_e64 v13, s94, v13
  v_and_b32_e64 v13, 1073741824, v13
  v_add3_u32 v4, v4, s30, v13
  v_add_u32_e64 v13, s22, v4
  v_mfma_f32_16x16x32_bf16 v[112:115], a[24:27], v[208:211], v[112:115]
  s_add_u32 m0, s29, 33280
  ds_read_b64_tr_b16 a[192:193], v8 offset:0
  ds_read_b64_tr_b16 a[196:197], v9 offset:0
  v_mfma_f32_16x16x32_bf16 v[120:123], a[24:27], v[212:215], v[120:123]
  buffer_load_dwordx4 v13, s[56:59], 0 offen lds
  ds_read_b64_tr_b16 a[20:21], v11 offset:49984
  ds_read_b64_tr_b16 a[22:23], v11 offset:51008
  ds_read_b64_tr_b16 a[200:201], v8 offset:64
  ds_read_b64_tr_b16 a[204:205], v9 offset:64
  buffer_load_dwordx4 v13, s[56:59], s90 offen offset:1024 lds
  v_accvgpr_read_b32 v28, a48
  v_fmac_f32 v24, v30, v20
  v_fmac_f32_e64 v25, v30, v21
  v_fma_f32 v24, -v31, v21, v24
  v_mfma_f32_16x16x32_bf16 v[124:127], a[28:31], v[212:215], v[124:127]
  s_waitcnt lgkmcnt(8)
  ds_read_b64_tr_b16 a[24:25], v10 offset:58304
  ds_read_b64_tr_b16 a[26:27], v10 offset:59328
  v_mfma_f32_16x16x32_bf16 v[116:119], a[28:31], v[208:211], v[116:119]
  v_fmac_f32_e64 v25, v31, v20
  v_accvgpr_read_b32 v18, a49
  v_mfma_f32_16x16x32_bf16 v[64:67], a[0:3], v[224:227], v[64:67]
  ds_write_b64 v28, v[24:25] offset:2048
  buffer_load_dwordx4 v13, s[56:59], s91 offen offset:2112 lds
  v_mfma_f32_16x16x32_bf16 v[72:75], a[0:3], v[228:231], v[72:75]
  ds_read_b64_tr_b16 a[28:29], v11 offset:58304
  ds_read_b64_tr_b16 a[30:31], v11 offset:59328
  s_waitcnt lgkmcnt(2)
  s_barrier
  v_mfma_f32_16x16x32_bf16 v[76:79], a[4:7], v[228:231], v[76:79]
  ds_read_b64_tr_b16 a[0:1], v10 offset:54080
  ds_read_b64_tr_b16 a[2:3], v10 offset:55104
  v_mfma_f32_16x16x32_bf16 v[68:71], a[4:7], v[224:227], v[68:71]
  ds_read_b128 v[24:27], v18 offset:2048
  ds_read_b128 v[28:31], v18 offset:2560
  buffer_load_dwordx4 v13, s[56:59], s92 offen offset:3136 lds
  v_accvgpr_read_b32 v22, a40
  v_accvgpr_read_b32 v23, a41
  v_mfma_f32_16x16x32_bf16 v[80:83], a[8:11], v[224:227], v[80:83]
  ds_read_b64_tr_b16 a[4:5], v11 offset:54080
  ds_read_b64_tr_b16 a[6:7], v11 offset:55104
  v_mfma_f32_16x16x32_bf16 v[88:91], a[8:11], v[228:231], v[88:91]
  s_waitcnt lgkmcnt(3)
  v_add_f32 v19, v24, v26
  v_add_f32 v20, v25, v27
  s_waitcnt lgkmcnt(2)
  v_add_f32_e64 v19, v19, v28
  v_mfma_f32_16x16x32_bf16 v[92:95], a[12:15], v[228:231], v[92:95]
  ds_read_b128 v[24:27], v18 offset:3072
  ds_read_b64_tr_b16 a[8:9], v10 offset:62400
  v_mfma_f32_16x16x32_bf16 v[84:87], a[12:15], v[224:227], v[84:87]
  s_add_u32 m0, s28, 0
  ds_read_b64_tr_b16 a[10:11], v10 offset:63424
  v_add_f32 v20, v20, v29
  v_add_f32 v19, v19, v30
  v_add_f32 v20, v20, v31
  v_mfma_f32_16x16x32_bf16 v[96:99], a[16:19], v[224:227], v[96:99]
  ds_read_b128 v[28:31], v18 offset:3584
  buffer_load_dwordx4 v0, s[68:71], s84 offen offset:2176 lds
  v_mfma_f32_16x16x32_bf16 v[104:107], a[16:19], v[228:231], v[104:107]
  ds_read_b64_tr_b16 a[12:13], v11 offset:62400
  ds_read_b64_tr_b16 a[14:15], v11 offset:63424
  s_waitcnt lgkmcnt(5)
  v_add_f32 v19, v19, v24
  v_add_f32 v20, v20, v25
  v_add_f32 v19, v19, v26
  v_add_f32_e64 v20, v20, v27
  v_mfma_f32_16x16x32_bf16 v[108:111], a[20:23], v[228:231], v[108:111]
  ds_read_b64_tr_b16 a[16:17], v10 offset:54144
  ds_read_b64_tr_b16 a[18:19], v10 offset:55168
  v_mfma_f32_16x16x32_bf16 v[100:103], a[20:23], v[224:227], v[100:103]
  buffer_load_dwordx4 v0, s[68:71], s87 offen offset:3264 lds
  s_waitcnt lgkmcnt(4)
  v_add_f32 v19, v19, v28
  v_add_f32_e64 v20, v20, v29
  v_add_f32_e64 v19, v19, v30
  v_add_f32_e64 v20, v20, v31
  v_mfma_f32_16x16x32_bf16 v[112:115], a[24:27], v[224:227], v[112:115]
  ds_read_b64_tr_b16 a[20:21], v11 offset:54144
  ds_read_b64_tr_b16 a[22:23], v11 offset:55168
  v_mfma_f32_16x16x32_bf16 v[120:123], a[24:27], v[228:231], v[120:123]
  s_add_u32 m0, s28, 17408
  v_fmac_f32_e64 v16, v19, v22
  v_fmac_f32_e64 v17, v19, v23
  v_fma_f32 v16, -v20, v23, v16
  v_fmac_f32 v17, v20, v22
  v_add_u32_e64 v0, s35, v3
  v_mfma_f32_16x16x32_bf16 v[124:127], a[28:31], v[228:231], v[124:127]
  s_waitcnt lgkmcnt(4)
  buffer_load_dwordx4 v0, s[68:71], 0 offen lds
  ds_read_b64_tr_b16 a[24:25], v10 offset:62464
  v_mfma_f32_16x16x32_bf16 v[116:119], a[28:31], v[224:227], v[116:119]
  ds_read_b64_tr_b16 a[26:27], v10 offset:63488
  buffer_load_dwordx4 v0, s[68:71], s86 offen offset:1088 lds
  v_mov_b32_e64 v31, s10
  v_fma_f32 v32, -v15, v17, v32
  v_fmac_f32_e64 v48, v15, v16
  v_fmac_f32_e64 v32, v14, v16
  v_mfma_f32_16x16x32_bf16 v[64:67], a[0:3], v[240:243], v[64:67]
  ds_read_b64_tr_b16 a[28:29], v11 offset:62464
  ds_read_b64_tr_b16 a[30:31], v11 offset:63488
  v_mfma_f32_16x16x32_bf16 v[72:75], a[0:3], v[244:247], v[72:75]
  v_fmac_f32_e64 v48, v14, v17
  v_accvgpr_read_b32 v16, a50
  v_accvgpr_read_b32 v22, a51
  v_xor_b32 v17, 16, v16
  v_mfma_f32_16x16x32_bf16 v[76:79], a[4:7], v[244:247], v[76:79]
  s_barrier
  ds_read_b64_tr_b16 a[0:1], v12 offset:0
  ds_read_b64_tr_b16 a[2:3], v12 offset:1024
  v_mfma_f32_16x16x32_bf16 v[68:71], a[4:7], v[240:243], v[68:71]
  buffer_load_dwordx4 v0, s[68:71], s84 offen offset:2176 lds
  v_xor_b32_e64 v23, 32, v22
  v_accvgpr_read_b32 v28, a53
  v_add_u32 v29, 8192, v28
  v_mfma_f32_16x16x32_bf16 v[80:83], a[8:11], v[240:243], v[80:83]
  ds_read_b64_tr_b16 a[4:5], v7 offset:0
  ds_read_b64_tr_b16 a[6:7], v7 offset:1024
  v_mfma_f32_16x16x32_bf16 v[88:91], a[8:11], v[244:247], v[88:91]
  buffer_load_dwordx4 v0, s[68:71], s87 offen offset:3264 lds
  v_fma_f32 v33, -v15, v48, v33
  v_fmac_f32 v49, v15, v32
  v_fmac_f32 v33, v14, v32
  v_fmac_f32 v49, v14, v48
  v_cvt_pk_bf16_f32 v32, v32, v33
  v_cvt_pk_bf16_f32 v48, -v48, -v49
  v_mfma_f32_16x16x32_bf16 v[92:95], a[12:15], v[244:247], v[92:95]
  s_waitcnt lgkmcnt(4)
  ds_read_b64_tr_b16 a[8:9], v12 offset:8320
  ds_read_b64_tr_b16 a[10:11], v12 offset:9344
  v_mfma_f32_16x16x32_bf16 v[84:87], a[12:15], v[240:243], v[84:87]
  s_add_u32 m0, s28, 34816
  v_fma_f32 v34, -v15, v49, v34
  v_fmac_f32 v50, v15, v33
  v_fmac_f32 v34, v14, v33
  v_fmac_f32 v50, v14, v49
  v_fma_f32 v35, -v15, v50, v35
  v_add_u32 v0, s36, v3
  v_mfma_f32_16x16x32_bf16 v[96:99], a[16:19], v[240:243], v[96:99]
  buffer_load_dwordx4 v0, s[68:71], 0 offen lds
  ds_read_b64_tr_b16 a[12:13], v7 offset:8320
  v_mfma_f32_16x16x32_bf16 v[104:107], a[16:19], v[244:247], v[104:107]
  ds_read_b64_tr_b16 a[14:15], v7 offset:9344
  buffer_load_dwordx4 v0, s[68:71], s86 offen offset:1088 lds
  v_fmac_f32 v51, v15, v34
  v_fmac_f32 v35, v14, v34
  v_fmac_f32_e64 v51, v14, v50
  v_cvt_pk_bf16_f32 v33, v34, v35
  v_cvt_pk_bf16_f32 v49, -v50, -v51
  v_mfma_f32_16x16x32_bf16 v[108:111], a[20:23], v[244:247], v[108:111]
  s_add_u32 m0, s29, 49920
  ds_read_b64_tr_b16 a[16:17], v12 offset:2048
  ds_read_b64_tr_b16 a[18:19], v12 offset:3072
  v_mfma_f32_16x16x32_bf16 v[100:103], a[20:23], v[240:243], v[100:103]
  v_fma_f32 v36, -v15, v51, v36
  v_fmac_f32_e64 v52, v15, v35
  v_fmac_f32_e64 v36, v14, v35
  v_fmac_f32_e64 v52, v14, v51
  v_fma_f32 v37, -v15, v52, v37
  v_add_u32_e64 v13, s23, v4
  v_mfma_f32_16x16x32_bf16 v[112:115], a[24:27], v[240:243], v[112:115]
  buffer_load_dwordx4 v13, s[56:59], 0 offen lds
  ds_read_b64_tr_b16 a[20:21], v7 offset:2048
  v_mfma_f32_16x16x32_bf16 v[120:123], a[24:27], v[244:247], v[120:123]
  ds_read_b64_tr_b16 a[22:23], v7 offset:3072
  v_fmac_f32_e64 v53, v15, v36
  v_fmac_f32_e64 v37, v14, v36
  v_fmac_f32 v53, v14, v52
  v_cvt_pk_bf16_f32 v34, v36, v37
  v_cvt_pk_bf16_f32 v50, -v52, -v53
  v_mfma_f32_16x16x32_bf16 v[124:127], a[28:31], v[244:247], v[124:127]
  s_waitcnt lgkmcnt(4)
  ds_read_b64_tr_b16 a[24:25], v12 offset:10368
  ds_read_b64_tr_b16 a[26:27], v12 offset:11392
  v_mfma_f32_16x16x32_bf16 v[116:119], a[28:31], v[240:243], v[116:119]
  buffer_load_dwordx4 v13, s[56:59], s90 offen offset:1024 lds
  v_fma_f32 v38, -v15, v53, v38
  v_fmac_f32 v54, v15, v37
  v_fmac_f32 v38, v14, v37
  v_fmac_f32_e64 v54, v14, v53
  v_fma_f32 v39, -v15, v54, v39
  v_mfma_f32_16x16x32_bf16 v[64:67], a[0:3], v[136:139], v[64:67]
  ds_read_b64_tr_b16 a[28:29], v7 offset:10368
  ds_read_b64_tr_b16 a[30:31], v7 offset:11392
  v_mfma_f32_16x16x32_bf16 v[72:75], a[0:3], v[140:143], v[72:75]
  buffer_load_dwordx4 v13, s[56:59], s91 offen offset:2112 lds
  v_fmac_f32 v55, v15, v38
  v_fmac_f32 v39, v14, v38
  v_fmac_f32_e64 v55, v14, v54
  v_cvt_pk_bf16_f32 v35, v38, v39
  v_cvt_pk_bf16_f32 v51, -v54, -v55
  v_mfma_f32_16x16x32_bf16 v[76:79], a[4:7], v[140:143], v[76:79]
  ds_read_b64_tr_b16 a[0:1], v12 offset:4160
  ds_read_b64_tr_b16 a[2:3], v12 offset:5184
  v_mfma_f32_16x16x32_bf16 v[68:71], a[4:7], v[136:139], v[68:71]
  v_fma_f32 v40, -v15, v55, v40
  v_fmac_f32 v56, v15, v39
  v_fmac_f32 v40, v14, v39
  v_fmac_f32_e64 v56, v14, v55
  v_fma_f32 v41, -v15, v56, v41
  v_mfma_f32_16x16x32_bf16 v[80:83], a[8:11], v[136:139], v[80:83]
  ds_read_b64_tr_b16 a[4:5], v7 offset:4160
  ds_read_b64_tr_b16 a[6:7], v7 offset:5184
  v_mfma_f32_16x16x32_bf16 v[88:91], a[8:11], v[140:143], v[88:91]
  buffer_load_dwordx4 v13, s[56:59], s92 offen offset:3136 lds
  v_fmac_f32_e64 v57, v15, v40
  v_fmac_f32_e64 v41, v14, v40
  v_fmac_f32 v57, v14, v56
  v_cvt_pk_bf16_f32 v36, v40, v41
  v_cvt_pk_bf16_f32 v52, -v56, -v57
  v_mfma_f32_16x16x32_bf16 v[92:95], a[12:15], v[140:143], v[92:95]
  s_waitcnt vmcnt(10) lgkmcnt(4)
  ds_read_b64_tr_b16 a[8:9], v12 offset:12480
  ds_read_b64_tr_b16 a[10:11], v12 offset:13504
  v_mfma_f32_16x16x32_bf16 v[84:87], a[12:15], v[136:139], v[84:87]
  s_add_u32 m0, s28, 34816
  ds_read_b64_tr_b16 a[194:195], v8 offset:2176
  ds_read_b64_tr_b16 a[198:199], v9 offset:2176
  buffer_load_dwordx4 v0, s[68:71], s84 offen offset:2176 lds
  v_fma_f32 v42, -v15, v57, v42
  v_fmac_f32 v58, v15, v41
  v_fmac_f32 v42, v14, v41
  v_fmac_f32_e64 v58, v14, v57
  v_fma_f32 v43, -v15, v58, v43
  v_mfma_f32_16x16x32_bf16 v[64:67], a[16:19], v[152:155], v[64:67]
  ds_read_b64_tr_b16 a[12:13], v7 offset:12480
  ds_read_b64_tr_b16 a[14:15], v7 offset:13504
  v_mfma_f32_16x16x32_bf16 v[72:75], a[16:19], v[156:159], v[72:75]
  ds_read_b64_tr_b16 a[202:203], v8 offset:2240
  ds_read_b64_tr_b16 a[206:207], v9 offset:2240
  buffer_load_dwordx4 v0, s[68:71], s87 offen offset:3264 lds
  v_fmac_f32_e64 v59, v15, v42
  v_fmac_f32_e64 v43, v14, v42
  v_fmac_f32 v59, v14, v58
  v_cvt_pk_bf16_f32 v37, v42, v43
  v_cvt_pk_bf16_f32 v53, -v58, -v59
  v_mfma_f32_16x16x32_bf16 v[76:79], a[20:23], v[156:159], v[76:79]
  s_waitcnt vmcnt(10)
  ds_read_b64_tr_b16 a[16:17], v12 offset:6208
  ds_read_b64_tr_b16 a[18:19], v12 offset:7232
  v_mfma_f32_16x16x32_bf16 v[68:71], a[20:23], v[152:155], v[68:71]
  s_add_u32 m0, s28, 52224
  ds_read_b64_tr_b16 a[208:209], v8 offset:17408
  ds_read_b64_tr_b16 a[212:213], v9 offset:17408
  v_fma_f32 v44, -v15, v59, v44
  v_fmac_f32 v60, v15, v43
  v_fmac_f32 v44, v14, v43
  v_fmac_f32 v60, v14, v59
  v_fma_f32 v45, -v15, v60, v45
  v_add_u32 v0, s37, v3
  v_mfma_f32_16x16x32_bf16 v[80:83], a[24:27], v[152:155], v[80:83]
  buffer_load_dwordx4 v0, s[68:71], 0 offen lds
  buffer_load_dwordx4 v0, s[68:71], s86 offen offset:1088 lds
  v_mfma_f32_16x16x32_bf16 v[88:91], a[24:27], v[156:159], v[88:91]
  ds_read_b64_tr_b16 a[20:21], v7 offset:6208
  ds_read_b64_tr_b16 a[22:23], v7 offset:7232
  ds_read_b64_tr_b16 a[216:217], v8 offset:17472
  ds_read_b64_tr_b16 a[220:221], v9 offset:17472
  buffer_load_dwordx4 v0, s[68:71], s84 offen offset:2176 lds
  v_fmac_f32 v61, v15, v44
  v_fmac_f32 v45, v14, v44
  v_fmac_f32 v61, v14, v60
  v_cvt_pk_bf16_f32 v38, v44, v45
  v_cvt_pk_bf16_f32 v54, -v60, -v61
  v_mfma_f32_16x16x32_bf16 v[92:95], a[28:31], v[156:159], v[92:95]
  s_waitcnt vmcnt(11) lgkmcnt(10)
  ds_read_b64_tr_b16 a[24:25], v12 offset:14528
  ds_read_b64_tr_b16 a[26:27], v12 offset:15552
  v_mfma_f32_16x16x32_bf16 v[84:87], a[28:31], v[152:155], v[84:87]
  ds_read_b64_tr_b16 a[210:211], v8 offset:19584
  ds_read_b64_tr_b16 a[214:215], v9 offset:19584
  buffer_load_dwordx4 v0, s[68:71], s87 offen offset:3264 lds
  v_fma_f32 v46, -v15, v61, v46
  v_fmac_f32 v62, v15, v45
  v_fmac_f32 v46, v14, v45
  v_fmac_f32 v62, v14, v61
  v_fma_f32 v47, -v15, v62, v47
  v_mfma_f32_16x16x32_bf16 v[64:67], a[0:3], v[168:171], v[64:67]
  ds_read_b64_tr_b16 a[28:29], v7 offset:14528
  ds_read_b64_tr_b16 a[30:31], v7 offset:15552
  v_mfma_f32_16x16x32_bf16 v[72:75], a[0:3], v[172:175], v[72:75]
  s_add_u32 m0, s28, 0
  ds_read_b64_tr_b16 a[218:219], v8 offset:19648
  ds_read_b64_tr_b16 a[222:223], v9 offset:19648
  v_fmac_f32 v63, v15, v46
  v_fmac_f32 v47, v14, v46
  v_fmac_f32_e64 v63, v14, v62
  v_cvt_pk_bf16_f32 v39, v46, v47
  v_cvt_pk_bf16_f32 v55, -v62, -v63
  v_add_u32 v0, s38, v3
  v_mfma_f32_16x16x32_bf16 v[76:79], a[4:7], v[172:175], v[76:79]
  buffer_load_dwordx4 v0, s[68:71], 0 offen lds
  buffer_load_dwordx4 v0, s[68:71], s86 offen offset:1088 lds
  v_mfma_f32_16x16x32_bf16 v[68:71], a[4:7], v[168:171], v[68:71]
  s_barrier
  ds_read_b64_tr_b16 a[0:1], v12 offset:16640
  ds_read_b64_tr_b16 a[2:3], v12 offset:17664
  ds_write_b128 v16, v[32:35]
  ds_write_b128 v17, v[36:39]
  ds_read_b64_tr_b16 v[40:41], v22 offset:0
  s_waitcnt vmcnt(12)
  ds_read_b64_tr_b16 a[224:225], v8 offset:34816
  ds_read_b64_tr_b16 a[228:229], v9 offset:34816
  s_waitcnt lgkmcnt(15)
  buffer_load_dwordx4 v0, s[68:71], s84 offen offset:2176 lds
  v_mfma_f32_16x16x32_bf16 v[80:83], a[8:11], v[168:171], v[80:83]
  ds_read_b64_tr_b16 a[4:5], v7 offset:16640
  ds_read_b64_tr_b16 a[6:7], v7 offset:17664
  v_mfma_f32_16x16x32_bf16 v[88:91], a[8:11], v[172:175], v[88:91]
  ds_read_b64_tr_b16 v[42:43], v23 offset:256
  ds_read_b64_tr_b16 v[44:45], v22 offset:8
  ds_read_b64_tr_b16 v[46:47], v23 offset:264
  ds_read_b64_tr_b16 a[232:233], v8 offset:34880
  ds_read_b64_tr_b16 a[236:237], v9 offset:34880
  buffer_load_dwordx4 v0, s[68:71], s87 offen offset:3264 lds
  v_mfma_f32_16x16x32_bf16 v[92:95], a[12:15], v[172:175], v[92:95]
  s_waitcnt lgkmcnt(15)
  ds_read_b64_tr_b16 a[8:9], v12 offset:24960
  ds_read_b64_tr_b16 a[10:11], v12 offset:25984
  s_nop 0
  v_mfma_f32_16x16x32_bf16 v[84:87], a[12:15], v[168:171], v[84:87]
  s_add_u32 m0, s28, 17408
  ds_write_b128 v16, v[48:51]
  ds_write_b128 v17, v[52:55]
  ds_read_b64_tr_b16 v[56:57], v22 offset:0
  v_add_u32_e64 v0, s39, v3
  v_mfma_f32_16x16x32_bf16 v[64:67], a[16:19], v[184:187], v[64:67]
  buffer_load_dwordx4 v0, s[68:71], 0 offen lds
  ds_read_b64_tr_b16 a[12:13], v7 offset:24960
  v_mfma_f32_16x16x32_bf16 v[72:75], a[16:19], v[188:191], v[72:75]
  ds_read_b64_tr_b16 a[14:15], v7 offset:25984
  ds_read_b64_tr_b16 v[58:59], v23 offset:256
  ds_read_b64_tr_b16 v[60:61], v22 offset:8
  ds_read_b64_tr_b16 v[62:63], v23 offset:264
  buffer_load_dwordx4 v0, s[68:71], s86 offen offset:1088 lds
  v_mfma_f32_16x16x32_bf16 v[76:79], a[20:23], v[188:191], v[76:79]
  s_waitcnt vmcnt(10)
  ds_read_b64_tr_b16 a[16:17], v12 offset:18688
  ds_read_b64_tr_b16 a[18:19], v12 offset:19712
  v_mfma_f32_16x16x32_bf16 v[68:71], a[20:23], v[184:187], v[68:71]
  s_add_u32 m0, s29, 0
  ds_read_b64_tr_b16 a[226:227], v8 offset:36992
  ds_read_b64_tr_b16 a[230:231], v9 offset:36992
  v_accvgpr_read_b32 v20, a54
  v_accvgpr_read_b32 v21, a54
  v_accvgpr_read_b32 v25, a55
  v_add_u32_e64 v13, s24, v4
  v_mfma_f32_16x16x32_bf16 v[80:83], a[24:27], v[184:187], v[80:83]
  buffer_load_dwordx4 v13, s[56:59], 0 offen lds
  ds_read_b64_tr_b16 a[20:21], v7 offset:18688
  v_mfma_f32_16x16x32_bf16 v[88:91], a[24:27], v[188:191], v[88:91]
  ds_read_b64_tr_b16 a[22:23], v7 offset:19712
  ds_read_b64_tr_b16 a[234:235], v8 offset:37056
  ds_read_b64_tr_b16 a[238:239], v9 offset:37056
  v_accvgpr_read_b32 v26, a55
  v_accvgpr_read_b32 v27, a56
  v_mfma_f32_16x16x32_bf16 v[92:95], a[28:31], v[188:191], v[92:95]
  s_waitcnt lgkmcnt(11)
  ds_read_b64_tr_b16 a[24:25], v12 offset:27008
  ds_read_b64_tr_b16 a[26:27], v12 offset:28032
  v_mfma_f32_16x16x32_bf16 v[84:87], a[28:31], v[184:187], v[84:87]
  s_nop 0
  buffer_store_dwordx4 v[40:43], v28, s[72:75], s14 offen sc1
  v_accvgpr_read_b32 v14, a56
  v_permlane32_swap_b32 v20, v21
  v_mfma_f32_16x16x32_bf16 v[64:67], a[0:3], v[200:203], v[64:67]
  s_waitcnt vmcnt(10)
  ds_read_b64_tr_b16 a[28:29], v7 offset:27008
  ds_read_b64_tr_b16 a[30:31], v7 offset:28032
  v_mfma_f32_16x16x32_bf16 v[72:75], a[0:3], v[204:207], v[72:75]
  ds_read_b64_tr_b16 a[240:241], v8 offset:52224
  ds_read_b64_tr_b16 a[244:245], v9 offset:52224
  v_permlane32_swap_b32 v25, v26
  v_permlane32_swap_b32 v27, v14
  v_mfma_f32_16x16x32_bf16 v[76:79], a[4:7], v[204:207], v[76:79]
  ds_read_b64_tr_b16 a[0:1], v12 offset:20800
  ds_read_b64_tr_b16 a[2:3], v12 offset:21824
  v_mfma_f32_16x16x32_bf16 v[68:71], a[4:7], v[200:203], v[68:71]
  ds_read_b64_tr_b16 a[248:249], v8 offset:52288
  ds_read_b64_tr_b16 a[252:253], v9 offset:52288
  v_mfma_f32_16x16x32_bf16 v[80:83], a[8:11], v[200:203], v[80:83]
  ds_read_b64_tr_b16 a[4:5], v7 offset:20800
  ds_read_b64_tr_b16 a[6:7], v7 offset:21824
  v_mfma_f32_16x16x32_bf16 v[88:91], a[8:11], v[204:207], v[88:91]
  v_mfma_f32_16x16x32_bf16 v[92:95], a[12:15], v[204:207], v[92:95]
  s_waitcnt lgkmcnt(8)
  ds_read_b64_tr_b16 a[8:9], v12 offset:29120
  ds_read_b64_tr_b16 a[10:11], v12 offset:30144
  s_nop 0
  v_mfma_f32_16x16x32_bf16 v[84:87], a[12:15], v[200:203], v[84:87]
  buffer_store_dwordx4 v[44:47], v29, s[72:75], s14 offen sc1
  v_mfma_f32_16x16x32_bf16 v[64:67], a[16:19], v[216:219], v[64:67]
  ds_read_b64_tr_b16 a[12:13], v7 offset:29120
  ds_read_b64_tr_b16 a[14:15], v7 offset:30144
  v_mfma_f32_16x16x32_bf16 v[72:75], a[16:19], v[220:223], v[72:75]
  v_mfma_f32_16x16x32_bf16 v[76:79], a[20:23], v[220:223], v[76:79]
  ds_read_b64_tr_b16 a[16:17], v12 offset:22848
  ds_read_b64_tr_b16 a[18:19], v12 offset:23872
  v_mfma_f32_16x16x32_bf16 v[68:71], a[20:23], v[216:219], v[68:71]
  v_mfma_f32_16x16x32_bf16 v[80:83], a[24:27], v[216:219], v[80:83]
  s_waitcnt vmcnt(9)
  s_nop 0
  ds_read_b64_tr_b16 a[20:21], v7 offset:22848
  ds_read_b64_tr_b16 a[22:23], v7 offset:23872
  v_mfma_f32_16x16x32_bf16 v[88:91], a[24:27], v[220:223], v[88:91]
  ds_read_b64_tr_b16 a[242:243], v8 offset:54400
  ds_read_b64_tr_b16 a[246:247], v9 offset:54400
  v_mfma_f32_16x16x32_bf16 v[92:95], a[28:31], v[220:223], v[92:95]
  s_waitcnt lgkmcnt(6)
  ds_read_b64_tr_b16 a[24:25], v12 offset:31168
  ds_read_b64_tr_b16 a[26:27], v12 offset:32192
  v_mfma_f32_16x16x32_bf16 v[84:87], a[28:31], v[216:219], v[84:87]
  s_add_u32 s14, s14, 32768
  ds_read_b64_tr_b16 a[250:251], v8 offset:54464
  ds_read_b64_tr_b16 a[254:255], v9 offset:54464
  buffer_store_dwordx4 v[56:59], v28, s[72:75], s14 offen sc1
  v_mfma_f32_16x16x32_bf16 v[64:67], a[0:3], v[232:235], v[64:67]
  s_waitcnt vmcnt(8)
  ds_read_b64_tr_b16 a[28:29], v7 offset:31168
  ds_read_b64_tr_b16 a[30:31], v7 offset:32192
  v_mfma_f32_16x16x32_bf16 v[72:75], a[0:3], v[236:239], v[72:75]
  ds_read_b64_tr_b16 a[32:33], v8 offset:0
  ds_read_b64_tr_b16 a[36:37], v9 offset:0
  v_mfma_f32_16x16x32_bf16 v[76:79], a[4:7], v[236:239], v[76:79]
  s_lshr_b32 s3, s94, 30
  s_barrier
  ds_read_b64_tr_b16 a[0:1], v10 offset:33280
  ds_read_b64_tr_b16 a[2:3], v10 offset:34304
  v_mfma_f32_16x16x32_bf16 v[68:71], a[4:7], v[232:235], v[68:71]
  s_lshl_b32 s3, s3, 20
  ds_read_b64_tr_b16 a[40:41], v8 offset:64
  ds_read_b64_tr_b16 a[44:45], v9 offset:64
  v_add_u32 v12, s3, v12
  v_add_u32 v7, s3, v7
  v_mfma_f32_16x16x32_bf16 v[80:83], a[8:11], v[232:235], v[80:83]
  ds_read_b64_tr_b16 a[4:5], v11 offset:33280
  ds_read_b64_tr_b16 a[6:7], v11 offset:34304
  v_mfma_f32_16x16x32_bf16 v[88:91], a[8:11], v[236:239], v[88:91]
  v_mfma_f32_16x16x32_bf16 v[92:95], a[12:15], v[236:239], v[92:95]
  s_waitcnt vmcnt(6) lgkmcnt(8)
  ds_read_b64_tr_b16 a[8:9], v10 offset:41600
  ds_read_b64_tr_b16 a[10:11], v10 offset:42624
  v_mfma_f32_16x16x32_bf16 v[84:87], a[12:15], v[232:235], v[84:87]
  ds_read_b64_tr_b16 a[34:35], v8 offset:2176
  ds_read_b64_tr_b16 a[38:39], v9 offset:2176
  buffer_store_dwordx4 v[60:63], v29, s[72:75], s14 offen sc1
  v_mfma_f32_16x16x32_bf16 v[64:67], a[16:19], v[248:251], v[64:67]
  ds_read_b64_tr_b16 a[12:13], v11 offset:41600
  ds_read_b64_tr_b16 a[14:15], v11 offset:42624
  v_mfma_f32_16x16x32_bf16 v[72:75], a[16:19], v[252:255], v[72:75]
  ds_read_b64_tr_b16 a[42:43], v8 offset:2240
  ds_read_b64_tr_b16 a[46:47], v9 offset:2240
  v_mfma_f32_16x16x32_bf16 v[76:79], a[20:23], v[252:255], v[76:79]
  s_waitcnt vmcnt(5)
  s_nop 0
  ds_read_b64_tr_b16 a[16:17], v10 offset:33344
  ds_read_b64_tr_b16 a[18:19], v10 offset:34368
  v_mfma_f32_16x16x32_bf16 v[68:71], a[20:23], v[248:251], v[68:71]
  ds_read_b64_tr_b16 a[48:49], v8 offset:17408
  ds_read_b64_tr_b16 a[52:53], v9 offset:17408
  v_mfma_f32_16x16x32_bf16 v[80:83], a[24:27], v[248:251], v[80:83]
  ds_read_b64_tr_b16 a[20:21], v11 offset:33344
  ds_read_b64_tr_b16 a[22:23], v11 offset:34368
  v_mfma_f32_16x16x32_bf16 v[88:91], a[24:27], v[252:255], v[88:91]
  ds_read_b64_tr_b16 a[56:57], v8 offset:17472
  ds_read_b64_tr_b16 a[60:61], v9 offset:17472
  v_mfma_f32_16x16x32_bf16 v[92:95], a[28:31], v[252:255], v[92:95]
  s_waitcnt lgkmcnt(10)
  ds_read_b64_tr_b16 a[24:25], v10 offset:41664
  ds_read_b64_tr_b16 a[26:27], v10 offset:42688
  v_mfma_f32_16x16x32_bf16 v[84:87], a[28:31], v[248:251], v[84:87]
  s_nop 0
  buffer_load_dwordx4 v13, s[56:59], s90 offen offset:1024 lds
  v_mfma_f32_16x16x32_bf16 v[96:99], a[0:3], v[136:139], v[96:99]
  ds_read_b64_tr_b16 a[28:29], v11 offset:41664
  ds_read_b64_tr_b16 a[30:31], v11 offset:42688
  v_mfma_f32_16x16x32_bf16 v[104:107], a[0:3], v[140:143], v[104:107]
  v_mfma_f32_16x16x32_bf16 v[108:111], a[4:7], v[140:143], v[108:111]
  ds_read_b64_tr_b16 a[0:1], v10 offset:37440
  ds_read_b64_tr_b16 a[2:3], v10 offset:38464
  v_mfma_f32_16x16x32_bf16 v[100:103], a[4:7], v[136:139], v[100:103]
Lpad4:
  s_cbranch_execz Lret4
  buffer_load_dwordx4 v13, s[56:59], s91 offen offset:2112 lds
  v_mfma_f32_16x16x32_bf16 v[112:115], a[8:11], v[136:139], v[112:115]
  s_nop 0
  ds_read_b64_tr_b16 a[4:5], v11 offset:37440
  ds_read_b64_tr_b16 a[6:7], v11 offset:38464
  v_mfma_f32_16x16x32_bf16 v[120:123], a[8:11], v[140:143], v[120:123]
  v_mfma_f32_16x16x32_bf16 v[124:127], a[12:15], v[140:143], v[124:127]
  s_waitcnt lgkmcnt(4)
  s_nop 0
  ds_read_b64_tr_b16 a[8:9], v10 offset:45760
  ds_read_b64_tr_b16 a[10:11], v10 offset:46784
  v_mfma_f32_16x16x32_bf16 v[116:119], a[12:15], v[136:139], v[116:119]
  buffer_load_dwordx4 v13, s[56:59], s92 offen offset:3136 lds
  v_mfma_f32_16x16x32_bf16 v[32:35], a[16:19], v[136:139], 0
  ds_read_b64_tr_b16 a[12:13], v11 offset:45760
  ds_read_b64_tr_b16 a[14:15], v11 offset:46784
  v_mfma_f32_16x16x32_bf16 v[40:43], a[16:19], v[140:143], 0
  v_mfma_f32_16x16x32_bf16 v[44:47], a[20:23], v[140:143], 0
  ds_read_b64_tr_b16 a[16:17], v10 offset:37504
  ds_read_b64_tr_b16 a[18:19], v10 offset:38528
  v_mfma_f32_16x16x32_bf16 v[36:39], a[20:23], v[136:139], 0
  v_mfma_f32_16x16x32_bf16 v[48:51], a[24:27], v[136:139], 0
  s_add_u32 m0, s29, 16640
  ds_read_b64_tr_b16 a[20:21], v11 offset:37504
  ds_read_b64_tr_b16 a[22:23], v11 offset:38528
  v_mfma_f32_16x16x32_bf16 v[56:59], a[24:27], v[140:143], 0
  v_mul_f32 v18, v64, v64
  v_mul_f32 v19, v65, v65
  v_mul_f32_e64 v80, v64, v80
  v_mul_f32_e64 v81, v65, v81
  v_add_u32 v13, s25, v4
  v_mfma_f32_16x16x32_bf16 v[60:63], a[28:31], v[140:143], 0
  s_waitcnt lgkmcnt(4)
  buffer_load_dwordx4 v13, s[56:59], 0 offen lds
  ds_read_b64_tr_b16 a[24:25], v10 offset:45824
  v_mfma_f32_16x16x32_bf16 v[52:55], a[28:31], v[136:139], 0
  ds_read_b64_tr_b16 a[26:27], v10 offset:46848
  buffer_load_dwordx4 v13, s[56:59], s90 offen offset:1024 lds
  v_fma_f32 v18, v18, v20, v25
  v_fma_f32 v19, v19, v20, v25
  v_mul_f32_e64 v64, v64, v18
  v_mfma_f32_16x16x32_bf16 v[96:99], a[0:3], v[152:155], v[96:99]
  ds_read_b64_tr_b16 a[28:29], v11 offset:45824
  ds_read_b64_tr_b16 a[30:31], v11 offset:46848
  v_mfma_f32_16x16x32_bf16 v[104:107], a[0:3], v[156:159], v[104:107]
  v_mul_f32_e64 v65, v65, v19
  v_exp_f32_e64 v64, v64
  v_exp_f32 v65, v65
  v_mfma_f32_16x16x32_bf16 v[108:111], a[4:7], v[156:159], v[108:111]
  s_barrier
  ds_read_b64_tr_b16 a[0:1], v10 offset:49920
  ds_read_b64_tr_b16 a[2:3], v10 offset:50944
  v_mfma_f32_16x16x32_bf16 v[100:103], a[4:7], v[152:155], v[100:103]
  buffer_load_dwordx4 v13, s[56:59], s91 offen offset:2112 lds
  v_fma_f32 v64, v64, v27, v27
  v_fma_f32 v65, v65, v27, v27
  v_mfma_f32_16x16x32_bf16 v[112:115], a[8:11], v[152:155], v[112:115]
  ds_read_b64_tr_b16 a[4:5], v11 offset:49920
  ds_read_b64_tr_b16 a[6:7], v11 offset:50944
  v_mfma_f32_16x16x32_bf16 v[120:123], a[8:11], v[156:159], v[120:123]
  v_rcp_f32 v64, v64
  v_rcp_f32_e64 v65, v65
  v_mfma_f32_16x16x32_bf16 v[124:127], a[12:15], v[156:159], v[124:127]
  s_waitcnt lgkmcnt(4)
  ds_read_b64_tr_b16 a[8:9], v10 offset:58240
  ds_read_b64_tr_b16 a[10:11], v10 offset:59264
  v_mfma_f32_16x16x32_bf16 v[116:119], a[12:15], v[152:155], v[116:119]
  buffer_load_dwordx4 v13, s[56:59], s92 offen offset:3136 lds
  v_mul_f32 v80, v80, v64
  v_mul_f32 v81, v81, v65
  v_cvt_pk_bf16_f32 v64, v80, v81
  v_mfma_f32_16x16x32_bf16 v[32:35], a[16:19], v[152:155], v[32:35]
  ds_read_b64_tr_b16 a[12:13], v11 offset:58240
  ds_read_b64_tr_b16 a[14:15], v11 offset:59264
  v_mfma_f32_16x16x32_bf16 v[40:43], a[16:19], v[156:159], v[40:43]
  v_mul_f32 v18, v66, v66
  v_mul_f32 v19, v67, v67
  v_mul_f32_e64 v82, v66, v82
  v_mfma_f32_16x16x32_bf16 v[44:47], a[20:23], v[156:159], v[44:47]
  s_add_u32 m0, s29, 33280
  ds_read_b64_tr_b16 a[16:17], v10 offset:49984
  ds_read_b64_tr_b16 a[18:19], v10 offset:51008
  v_mfma_f32_16x16x32_bf16 v[36:39], a[20:23], v[152:155], v[36:39]
  v_mul_f32_e64 v83, v67, v83
  v_fma_f32 v18, v18, v20, v25
  v_fma_f32 v19, v19, v20, v25
  v_mul_f32_e64 v66, v66, v18
  v_add_u32_e64 v5, s45, v5
  v_add_u32_e64 v13, s26, v5
  v_mfma_f32_16x16x32_bf16 v[48:51], a[24:27], v[152:155], v[48:51]
  buffer_load_dwordx4 v13, s[56:59], 0 offen lds
  ds_read_b64_tr_b16 a[20:21], v11 offset:49984
  v_mfma_f32_16x16x32_bf16 v[56:59], a[24:27], v[156:159], v[56:59]
  ds_read_b64_tr_b16 a[22:23], v11 offset:51008
  v_mul_f32 v67, v67, v19
  v_exp_f32_e64 v66, v66
  v_mfma_f32_16x16x32_bf16 v[60:63], a[28:31], v[156:159], v[60:63]
  s_waitcnt lgkmcnt(4)
  ds_read_b64_tr_b16 a[24:25], v10 offset:58304
  ds_read_b64_tr_b16 a[26:27], v10 offset:59328
  v_mfma_f32_16x16x32_bf16 v[52:55], a[28:31], v[152:155], v[52:55]
  v_exp_f32_e64 v67, v67
  v_fma_f32 v66, v66, v27, v27
  v_fma_f32 v67, v67, v27, v27
  v_mfma_f32_16x16x32_bf16 v[96:99], a[0:3], v[168:171], v[96:99]
  ds_read_b64_tr_b16 a[28:29], v11 offset:58304
  ds_read_b64_tr_b16 a[30:31], v11 offset:59328
  v_mfma_f32_16x16x32_bf16 v[104:107], a[0:3], v[172:175], v[104:107]
  buffer_load_dwordx4 v13, s[56:59], s80 offen offset:1024 lds
  v_rcp_f32 v66, v66
  v_rcp_f32 v67, v67
  v_mfma_f32_16x16x32_bf16 v[108:111], a[4:7], v[172:175], v[108:111]
  ds_read_b64_tr_b16 a[0:1], v10 offset:54080
  ds_read_b64_tr_b16 a[2:3], v10 offset:55104
  v_mfma_f32_16x16x32_bf16 v[100:103], a[4:7], v[168:171], v[100:103]
  v_mul_f32_e64 v82, v82, v66
  v_mul_f32_e64 v83, v83, v67
  v_cvt_pk_bf16_f32 v65, v82, v83
  v_mfma_f32_16x16x32_bf16 v[112:115], a[8:11], v[168:171], v[112:115]
  ds_read_b64_tr_b16 a[4:5], v11 offset:54080
  ds_read_b64_tr_b16 a[6:7], v11 offset:55104
  v_mfma_f32_16x16x32_bf16 v[120:123], a[8:11], v[172:175], v[120:123]
  v_mul_f32_e64 v18, v68, v68
  v_mul_f32_e64 v19, v69, v69
  v_mul_f32 v84, v68, v84
  v_mfma_f32_16x16x32_bf16 v[124:127], a[12:15], v[172:175], v[124:127]
  s_waitcnt vmcnt(9) lgkmcnt(4)
  ds_read_b64_tr_b16 a[8:9], v10 offset:62400
  ds_read_b64_tr_b16 a[10:11], v10 offset:63424
  v_mfma_f32_16x16x32_bf16 v[116:119], a[12:15], v[168:171], v[116:119]
  v_mul_f32 v85, v69, v85
  v_fma_f32 v18, v18, v20, v25
  v_fma_f32 v19, v19, v20, v25
  s_mov_b64 exec, 0xff
  buffer_store_dwordx4 v[28:31], v1, s[72:75], s95 offen offset:0 sc1
  s_mov_b64 exec, -1
  v_mfma_f32_16x16x32_bf16 v[32:35], a[16:19], v[168:171], v[32:35]
  buffer_load_dwordx4 v13, s[56:59], s81 offen offset:2048 lds
  ds_read_b64_tr_b16 a[12:13], v11 offset:62400
  v_mfma_f32_16x16x32_bf16 v[40:43], a[16:19], v[172:175], v[40:43]
  ds_read_b64_tr_b16 a[14:15], v11 offset:63424
  v_mul_f32 v68, v68, v18
  v_mul_f32 v69, v69, v19
  v_exp_f32_e64 v68, v68
  v_mfma_f32_16x16x32_bf16 v[44:47], a[20:23], v[172:175], v[44:47]
  ds_read_b64_tr_b16 a[16:17], v10 offset:54144
  ds_read_b64_tr_b16 a[18:19], v10 offset:55168
  v_mfma_f32_16x16x32_bf16 v[36:39], a[20:23], v[168:171], v[36:39]
  v_exp_f32_e64 v69, v69
  v_fma_f32 v68, v68, v27, v27
  v_mfma_f32_16x16x32_bf16 v[48:51], a[24:27], v[168:171], v[48:51]
  ds_read_b64_tr_b16 a[20:21], v11 offset:54144
  ds_read_b64_tr_b16 a[22:23], v11 offset:55168
  v_mfma_f32_16x16x32_bf16 v[56:59], a[24:27], v[172:175], v[56:59]
  v_fma_f32 v69, v69, v27, v27
  v_rcp_f32 v68, v68
  v_rcp_f32_e64 v69, v69
  v_mfma_f32_16x16x32_bf16 v[60:63], a[28:31], v[172:175], v[60:63]
  s_waitcnt lgkmcnt(4)
  ds_read_b64_tr_b16 a[24:25], v10 offset:62464
  ds_read_b64_tr_b16 a[26:27], v10 offset:63488
  v_mfma_f32_16x16x32_bf16 v[52:55], a[28:31], v[168:171], v[52:55]
  buffer_load_dwordx4 v13, s[56:59], s82 offen offset:3072 lds
  v_mul_f32 v84, v84, v68
  v_mul_f32 v85, v85, v69
  v_mfma_f32_16x16x32_bf16 v[96:99], a[0:3], v[184:187], v[96:99]
  ds_read_b64_tr_b16 a[28:29], v11 offset:62464
  ds_read_b64_tr_b16 a[30:31], v11 offset:63488
  v_mfma_f32_16x16x32_bf16 v[104:107], a[0:3], v[188:191], v[104:107]
  v_cvt_pk_bf16_f32 v66, v84, v85
  v_mul_f32 v18, v70, v70
  v_mul_f32 v19, v71, v71
  v_mul_f32 v86, v70, v86
  v_mfma_f32_16x16x32_bf16 v[108:111], a[4:7], v[188:191], v[108:111]
  s_waitcnt vmcnt(9)
  s_barrier
  ds_read_b64_tr_b16 a[0:1], v10 offset:0
  ds_read_b64_tr_b16 a[2:3], v10 offset:1024
  v_mfma_f32_16x16x32_bf16 v[100:103], a[4:7], v[184:187], v[100:103]
  v_mul_f32 v87, v71, v87
  v_fma_f32 v18, v18, v20, v25
  v_fma_f32 v19, v19, v20, v25
  v_mfma_f32_16x16x32_bf16 v[112:115], a[8:11], v[184:187], v[112:115]
  s_add_u32 m0, s28, 17408
  ds_read_b64_tr_b16 a[4:5], v11 offset:0
  ds_read_b64_tr_b16 a[6:7], v11 offset:1024
  v_mfma_f32_16x16x32_bf16 v[120:123], a[8:11], v[188:191], v[120:123]
  buffer_load_dwordx4 v0, s[68:71], s84 offen offset:2176 lds
  v_mul_f32 v70, v70, v18
  v_mul_f32 v71, v71, v19
  v_exp_f32 v70, v70
  v_mfma_f32_16x16x32_bf16 v[124:127], a[12:15], v[188:191], v[124:127]
  s_waitcnt lgkmcnt(4)
  ds_read_b64_tr_b16 a[8:9], v10 offset:8320
  ds_read_b64_tr_b16 a[10:11], v10 offset:9344
  v_mfma_f32_16x16x32_bf16 v[116:119], a[12:15], v[184:187], v[116:119]
  v_exp_f32_e64 v71, v71
  v_fma_f32 v70, v70, v27, v27
  v_mfma_f32_16x16x32_bf16 v[32:35], a[16:19], v[184:187], v[32:35]
  ds_read_b64_tr_b16 a[12:13], v11 offset:8320
  ds_read_b64_tr_b16 a[14:15], v11 offset:9344
  v_mfma_f32_16x16x32_bf16 v[40:43], a[16:19], v[188:191], v[40:43]
  buffer_load_dwordx4 v0, s[68:71], s87 offen offset:3264 lds
  v_fma_f32 v71, v71, v27, v27
  v_rcp_f32_e64 v70, v70
  v_mfma_f32_16x16x32_bf16 v[44:47], a[20:23], v[188:191], v[44:47]
  s_add_u32 m0, s29, 49920
  ds_read_b64_tr_b16 a[16:17], v10 offset:64
  ds_read_b64_tr_b16 a[18:19], v10 offset:1088
  v_mfma_f32_16x16x32_bf16 v[36:39], a[20:23], v[184:187], v[36:39]
  v_rcp_f32 v71, v71
  v_mul_f32 v86, v86, v70
  v_mul_f32 v87, v87, v71
  v_add_u32 v13, s27, v5
  v_mfma_f32_16x16x32_bf16 v[48:51], a[24:27], v[184:187], v[48:51]
  buffer_load_dwordx4 v13, s[56:59], 0 offen lds
  ds_read_b64_tr_b16 a[20:21], v11 offset:64
  v_mfma_f32_16x16x32_bf16 v[56:59], a[24:27], v[188:191], v[56:59]
  ds_read_b64_tr_b16 a[22:23], v11 offset:1088
  v_cvt_pk_bf16_f32 v67, v86, v87
  v_mul_f32 v18, v72, v72
  v_mul_f32_e64 v19, v73, v73
  v_mfma_f32_16x16x32_bf16 v[60:63], a[28:31], v[188:191], v[60:63]
  s_waitcnt lgkmcnt(4)
  ds_read_b64_tr_b16 a[24:25], v10 offset:8384
  ds_read_b64_tr_b16 a[26:27], v10 offset:9408
  v_mfma_f32_16x16x32_bf16 v[52:55], a[28:31], v[184:187], v[52:55]
  v_mul_f32 v88, v72, v88
  v_mul_f32 v89, v73, v89
  v_fma_f32 v18, v18, v21, v26
  v_fma_f32 v19, v19, v21, v26
  v_mfma_f32_16x16x32_bf16 v[96:99], a[0:3], v[200:203], v[96:99]
  ds_read_b64_tr_b16 a[28:29], v11 offset:8384
  ds_read_b64_tr_b16 a[30:31], v11 offset:9408
  v_mfma_f32_16x16x32_bf16 v[104:107], a[0:3], v[204:207], v[104:107]
  buffer_load_dwordx4 v13, s[56:59], s80 offen offset:1024 lds
  v_mul_f32_e64 v72, v72, v18
  v_mul_f32_e64 v73, v73, v19
  v_exp_f32_e64 v72, v72
  v_mfma_f32_16x16x32_bf16 v[108:111], a[4:7], v[204:207], v[108:111]
  ds_read_b64_tr_b16 a[0:1], v10 offset:4160
  ds_read_b64_tr_b16 a[2:3], v10 offset:5184
  v_mfma_f32_16x16x32_bf16 v[100:103], a[4:7], v[200:203], v[100:103]
  v_exp_f32_e64 v73, v73
  v_mfma_f32_16x16x32_bf16 v[112:115], a[8:11], v[200:203], v[112:115]
  ds_read_b64_tr_b16 a[4:5], v11 offset:4160
  ds_read_b64_tr_b16 a[6:7], v11 offset:5184
  v_mfma_f32_16x16x32_bf16 v[120:123], a[8:11], v[204:207], v[120:123]
  v_fma_f32 v72, v72, v14, v14
  v_fma_f32 v73, v73, v14, v14
  v_rcp_f32 v72, v72
  v_mfma_f32_16x16x32_bf16 v[124:127], a[12:15], v[204:207], v[124:127]
  s_waitcnt lgkmcnt(4)
  ds_read_b64_tr_b16 a[8:9], v10 offset:12480
  ds_read_b64_tr_b16 a[10:11], v10 offset:13504
  v_mfma_f32_16x16x32_bf16 v[116:119], a[12:15], v[200:203], v[116:119]
  v_rcp_f32 v73, v73
  v_mul_f32 v88, v88, v72
  v_mfma_f32_16x16x32_bf16 v[32:35], a[16:19], v[200:203], v[32:35]
  ds_read_b64_tr_b16 a[12:13], v11 offset:12480
  ds_read_b64_tr_b16 a[14:15], v11 offset:13504
  v_mfma_f32_16x16x32_bf16 v[40:43], a[16:19], v[204:207], v[40:43]
  buffer_load_dwordx4 v13, s[56:59], s81 offen offset:2048 lds
  v_mul_f32_e64 v89, v89, v73
  v_cvt_pk_bf16_f32 v72, v88, v89
  v_mul_f32 v18, v74, v74
  v_mul_f32 v19, v75, v75
  v_mfma_f32_16x16x32_bf16 v[44:47], a[20:23], v[204:207], v[44:47]
  ds_read_b64_tr_b16 a[16:17], v10 offset:4224
  ds_read_b64_tr_b16 a[18:19], v10 offset:5248
  v_mfma_f32_16x16x32_bf16 v[36:39], a[20:23], v[200:203], v[36:39]
  v_mul_f32 v90, v74, v90
  v_mul_f32 v91, v75, v91
  v_fma_f32 v18, v18, v21, v26
  v_mfma_f32_16x16x32_bf16 v[48:51], a[24:27], v[200:203], v[48:51]
  ds_read_b64_tr_b16 a[20:21], v11 offset:4224
  ds_read_b64_tr_b16 a[22:23], v11 offset:5248
  v_mfma_f32_16x16x32_bf16 v[56:59], a[24:27], v[204:207], v[56:59]
  v_fma_f32 v19, v19, v21, v26
  v_mul_f32 v74, v74, v18
  v_mul_f32 v75, v75, v19
  v_exp_f32 v74, v74
  v_mfma_f32_16x16x32_bf16 v[60:63], a[28:31], v[204:207], v[60:63]
  s_waitcnt lgkmcnt(4)
  ds_read_b64_tr_b16 a[24:25], v10 offset:12544
  ds_read_b64_tr_b16 a[26:27], v10 offset:13568
  v_mfma_f32_16x16x32_bf16 v[52:55], a[28:31], v[200:203], v[52:55]
  v_exp_f32_e64 v75, v75
  v_mfma_f32_16x16x32_bf16 v[96:99], a[0:3], v[216:219], v[96:99]
  ds_read_b64_tr_b16 a[28:29], v11 offset:12544
  ds_read_b64_tr_b16 a[30:31], v11 offset:13568
  v_mfma_f32_16x16x32_bf16 v[104:107], a[0:3], v[220:223], v[104:107]
  buffer_load_dwordx4 v13, s[56:59], s82 offen offset:3072 lds
  v_fma_f32 v74, v74, v14, v14
  v_fma_f32 v75, v75, v14, v14
  v_rcp_f32_e64 v74, v74
  v_mfma_f32_16x16x32_bf16 v[108:111], a[4:7], v[220:223], v[108:111]
  s_waitcnt vmcnt(11)
  s_barrier
  ds_read_b64_tr_b16 a[0:1], v10 offset:16640
  ds_read_b64_tr_b16 a[2:3], v10 offset:17664
  v_mfma_f32_16x16x32_bf16 v[100:103], a[4:7], v[216:219], v[100:103]
  v_rcp_f32 v75, v75
  v_mul_f32 v90, v90, v74
  v_mfma_f32_16x16x32_bf16 v[112:115], a[8:11], v[216:219], v[112:115]
  ds_read_b64_tr_b16 a[4:5], v11 offset:16640
  ds_read_b64_tr_b16 a[6:7], v11 offset:17664
  v_mfma_f32_16x16x32_bf16 v[120:123], a[8:11], v[220:223], v[120:123]
  v_mul_f32_e64 v91, v91, v75
  v_cvt_pk_bf16_f32 v73, v90, v91
  v_mul_f32 v18, v76, v76
  v_mfma_f32_16x16x32_bf16 v[124:127], a[12:15], v[220:223], v[124:127]
  s_waitcnt lgkmcnt(4)
  ds_read_b64_tr_b16 a[8:9], v10 offset:24960
  ds_read_b64_tr_b16 a[10:11], v10 offset:25984
  v_mfma_f32_16x16x32_bf16 v[116:119], a[12:15], v[216:219], v[116:119]
  s_add_u32 m0, s28, 34816
  v_mul_f32 v19, v77, v77
  v_mul_f32 v92, v76, v92
  v_mul_f32_e64 v93, v77, v93
  v_fma_f32 v18, v18, v21, v26
  v_add_u32_e64 v0, s40, v3
  v_mfma_f32_16x16x32_bf16 v[32:35], a[16:19], v[216:219], v[32:35]
  buffer_load_dwordx4 v0, s[68:71], 0 offen lds
  ds_read_b64_tr_b16 a[12:13], v11 offset:24960
  v_mfma_f32_16x16x32_bf16 v[40:43], a[16:19], v[220:223], v[40:43]
  ds_read_b64_tr_b16 a[14:15], v11 offset:25984
  buffer_load_dwordx4 v0, s[68:71], s86 offen offset:1088 lds
  v_fma_f32 v19, v19, v21, v26
  v_mul_f32 v76, v76, v18
  v_mul_f32_e64 v77, v77, v19
  v_mfma_f32_16x16x32_bf16 v[44:47], a[20:23], v[220:223], v[44:47]
  s_waitcnt vmcnt(6)
  ds_read_b64_tr_b16 a[16:17], v10 offset:16704
  ds_read_b64_tr_b16 a[18:19], v10 offset:17728
  v_mfma_f32_16x16x32_bf16 v[36:39], a[20:23], v[216:219], v[36:39]
  ds_read_b64_tr_b16 a[50:51], v8 offset:19584
  ds_read_b64_tr_b16 a[54:55], v9 offset:19584
  buffer_load_dwordx4 v0, s[68:71], s84 offen offset:2176 lds
  v_exp_f32 v76, v76
  v_exp_f32 v77, v77
  v_mfma_f32_16x16x32_bf16 v[48:51], a[24:27], v[216:219], v[48:51]
  ds_read_b64_tr_b16 a[20:21], v11 offset:16704
  ds_read_b64_tr_b16 a[22:23], v11 offset:17728
  v_mfma_f32_16x16x32_bf16 v[56:59], a[24:27], v[220:223], v[56:59]
  ds_read_b64_tr_b16 a[58:59], v8 offset:19648
  ds_read_b64_tr_b16 a[62:63], v9 offset:19648
  buffer_load_dwordx4 v0, s[68:71], s87 offen offset:3264 lds
  v_fma_f32 v76, v76, v14, v14
  v_fma_f32 v77, v77, v14, v14
  v_rcp_f32 v76, v76
  v_mfma_f32_16x16x32_bf16 v[60:63], a[28:31], v[220:223], v[60:63]
  s_waitcnt lgkmcnt(8)
  ds_read_b64_tr_b16 a[24:25], v10 offset:25024
  ds_read_b64_tr_b16 a[26:27], v10 offset:26048
  v_mfma_f32_16x16x32_bf16 v[52:55], a[28:31], v[216:219], v[52:55]
  v_rcp_f32_e64 v77, v77
  v_mfma_f32_16x16x32_bf16 v[96:99], a[0:3], v[232:235], v[96:99]
  ds_read_b64_tr_b16 a[28:29], v11 offset:25024
  ds_read_b64_tr_b16 a[30:31], v11 offset:26048
  v_mfma_f32_16x16x32_bf16 v[104:107], a[0:3], v[236:239], v[104:107]
  s_add_u32 m0, s28, 52224
  v_mul_f32 v92, v92, v76
  v_mul_f32 v93, v93, v77
  v_cvt_pk_bf16_f32 v74, v92, v93
  v_mul_f32 v18, v78, v78
  v_add_u32 v0, s41, v3
  v_mfma_f32_16x16x32_bf16 v[108:111], a[4:7], v[236:239], v[108:111]
  buffer_load_dwordx4 v0, s[68:71], 0 offen lds
  ds_read_b64_tr_b16 a[0:1], v10 offset:20800
  v_mfma_f32_16x16x32_bf16 v[100:103], a[4:7], v[232:235], v[100:103]
  ds_read_b64_tr_b16 a[2:3], v10 offset:21824
  buffer_load_dwordx4 v0, s[68:71], s86 offen offset:1088 lds
  v_mul_f32 v19, v79, v79
  v_mul_f32 v94, v78, v94
  v_mul_f32_e64 v95, v79, v95
  v_mfma_f32_16x16x32_bf16 v[112:115], a[8:11], v[232:235], v[112:115]
  ds_read_b64_tr_b16 a[4:5], v11 offset:20800
  ds_read_b64_tr_b16 a[6:7], v11 offset:21824
  v_mfma_f32_16x16x32_bf16 v[120:123], a[8:11], v[236:239], v[120:123]
  v_fma_f32 v18, v18, v21, v26
  v_fma_f32 v19, v19, v21, v26
  v_mul_f32 v78, v78, v18
  v_mul_f32_e64 v79, v79, v19
  v_mfma_f32_16x16x32_bf16 v[124:127], a[12:15], v[236:239], v[124:127]
  s_waitcnt lgkmcnt(4)
  ds_read_b64_tr_b16 a[8:9], v10 offset:29120
  ds_read_b64_tr_b16 a[10:11], v10 offset:30144
  v_mfma_f32_16x16x32_bf16 v[116:119], a[12:15], v[232:235], v[116:119]
  buffer_load_dwordx4 v0, s[68:71], s84 offen offset:2176 lds
  v_exp_f32 v78, v78
  v_exp_f32 v79, v79
  v_mfma_f32_16x16x32_bf16 v[32:35], a[16:19], v[232:235], v[32:35]
  ds_read_b64_tr_b16 a[12:13], v11 offset:29120
  ds_read_b64_tr_b16 a[14:15], v11 offset:30144
  v_mfma_f32_16x16x32_bf16 v[40:43], a[16:19], v[236:239], v[40:43]
  buffer_load_dwordx4 v0, s[68:71], s87 offen offset:3264 lds
  v_fma_f32 v78, v78, v14, v14
  v_fma_f32 v79, v79, v14, v14
  v_rcp_f32_e64 v78, v78
  v_mfma_f32_16x16x32_bf16 v[44:47], a[20:23], v[236:239], v[44:47]
  ds_read_b64_tr_b16 a[16:17], v10 offset:20864
  ds_read_b64_tr_b16 a[18:19], v10 offset:21888
  v_mfma_f32_16x16x32_bf16 v[36:39], a[20:23], v[232:235], v[36:39]
  v_rcp_f32_e64 v79, v79
  v_mfma_f32_16x16x32_bf16 v[48:51], a[24:27], v[232:235], v[48:51]
  s_add_u32 s31, s47, 1048576
  ds_read_b64_tr_b16 a[20:21], v11 offset:20864
  ds_read_b64_tr_b16 a[22:23], v11 offset:21888
  v_mfma_f32_16x16x32_bf16 v[56:59], a[24:27], v[236:239], v[56:59]
  buffer_store_dwordx4 v[64:67], v28, s[72:75], s31 offen sc1
  v_mul_f32_e64 v94, v94, v78
  v_mul_f32 v95, v95, v79
  v_cvt_pk_bf16_f32 v75, v94, v95
  v_mfma_f32_16x16x32_bf16 v[60:63], a[28:31], v[236:239], v[60:63]
  s_waitcnt lgkmcnt(4)
  ds_read_b64_tr_b16 a[24:25], v10 offset:29184
  ds_read_b64_tr_b16 a[26:27], v10 offset:30208
  v_mfma_f32_16x16x32_bf16 v[52:55], a[28:31], v[232:235], v[52:55]
  v_mfma_f32_16x16x32_bf16 v[96:99], a[0:3], v[248:251], v[96:99]
  ds_read_b64_tr_b16 a[28:29], v11 offset:29184
  ds_read_b64_tr_b16 a[30:31], v11 offset:30208
  v_mfma_f32_16x16x32_bf16 v[104:107], a[0:3], v[252:255], v[104:107]
  v_mfma_f32_16x16x32_bf16 v[108:111], a[4:7], v[252:255], v[108:111]
  s_barrier
  ds_read_b64_tr_b16 a[0:1], v12 offset:33280
  ds_read_b64_tr_b16 a[2:3], v12 offset:34304
  v_mfma_f32_16x16x32_bf16 v[100:103], a[4:7], v[248:251], v[100:103]
  v_mfma_f32_16x16x32_bf16 v[112:115], a[8:11], v[248:251], v[112:115]
  ds_read_b64_tr_b16 a[4:5], v7 offset:33280
  ds_read_b64_tr_b16 a[6:7], v7 offset:34304
  v_mfma_f32_16x16x32_bf16 v[120:123], a[8:11], v[252:255], v[120:123]
  v_mfma_f32_16x16x32_bf16 v[124:127], a[12:15], v[252:255], v[124:127]
  s_waitcnt lgkmcnt(4)
  ds_read_b64_tr_b16 a[8:9], v12 offset:41600
  ds_read_b64_tr_b16 a[10:11], v12 offset:42624
  v_mfma_f32_16x16x32_bf16 v[116:119], a[12:15], v[248:251], v[116:119]
  buffer_store_dwordx4 v[72:75], v29, s[72:75], s31 offen sc1
  v_mfma_f32_16x16x32_bf16 v[32:35], a[16:19], v[248:251], v[32:35]
  ds_read_b64_tr_b16 a[12:13], v7 offset:41600
  ds_read_b64_tr_b16 a[14:15], v7 offset:42624
  v_mfma_f32_16x16x32_bf16 v[40:43], a[16:19], v[252:255], v[40:43]
  v_mfma_f32_16x16x32_bf16 v[44:47], a[20:23], v[252:255], v[44:47]
  ds_read_b64_tr_b16 a[16:17], v12 offset:35328
  ds_read_b64_tr_b16 a[18:19], v12 offset:36352
  v_mfma_f32_16x16x32_bf16 v[36:39], a[20:23], v[248:251], v[36:39]
  v_mfma_f32_16x16x32_bf16 v[48:51], a[24:27], v[248:251], v[48:51]
  ds_read_b64_tr_b16 a[20:21], v7 offset:35328
  ds_read_b64_tr_b16 a[22:23], v7 offset:36352
  v_mfma_f32_16x16x32_bf16 v[56:59], a[24:27], v[252:255], v[56:59]
  v_mfma_f32_16x16x32_bf16 v[60:63], a[28:31], v[252:255], v[60:63]
  s_waitcnt lgkmcnt(4)
  ds_read_b64_tr_b16 a[24:25], v12 offset:43648
  ds_read_b64_tr_b16 a[26:27], v12 offset:44672
  v_mfma_f32_16x16x32_bf16 v[52:55], a[28:31], v[248:251], v[52:55]
  v_lshlrev_b32_e64 v24, 3, v1
  s_mov_b64 exec, 0xff
  buffer_load_dword v24, v24, s[72:75], s98 offen offset:12 sc1
  s_mov_b64 exec, -1
  v_mfma_f32_16x16x32_bf16 v[32:35], a[0:3], v[128:131], v[32:35]
  ds_read_b64_tr_b16 a[28:29], v7 offset:43648
  ds_read_b64_tr_b16 a[30:31], v7 offset:44672
  v_mfma_f32_16x16x32_bf16 v[40:43], a[0:3], v[132:135], v[40:43]
  v_mfma_f32_16x16x32_bf16 v[44:47], a[4:7], v[132:135], v[44:47]
  ds_read_b64_tr_b16 a[0:1], v12 offset:37440
  ds_read_b64_tr_b16 a[2:3], v12 offset:38464
  v_mfma_f32_16x16x32_bf16 v[36:39], a[4:7], v[128:131], v[36:39]
  s_add_u32 m0, s28, 0
  v_mul_f32 v18, v96, v96
  v_mul_f32 v19, v97, v97
  v_mul_f32 v112, v96, v112
  v_mul_f32_e64 v113, v97, v113
  v_fma_f32 v18, v18, v20, v25
  v_fma_f32 v19, v19, v20, v25
  v_mul_f32_e64 v96, v96, v18
  v_add_u32_e64 v0, s42, v3
  v_mfma_f32_16x16x32_bf16 v[48:51], a[8:11], v[128:131], v[48:51]
  buffer_load_dwordx4 v0, s[68:71], 0 offen lds
  buffer_load_dwordx4 v0, s[68:71], s86 offen offset:1088 lds
  v_mfma_f32_16x16x32_bf16 v[56:59], a[8:11], v[132:135], v[56:59]
  ds_read_b64_tr_b16 a[4:5], v7 offset:37440
  ds_read_b64_tr_b16 a[6:7], v7 offset:38464
  buffer_load_dwordx4 v0, s[68:71], s84 offen offset:2176 lds
  v_mul_f32_e64 v97, v97, v19
  v_exp_f32_e64 v96, v96
  v_exp_f32 v97, v97
  v_fma_f32 v96, v96, v27, v27
  v_fma_f32 v97, v97, v27, v27
  v_mfma_f32_16x16x32_bf16 v[60:63], a[12:15], v[132:135], v[60:63]
  s_waitcnt lgkmcnt(4)
  ds_read_b64_tr_b16 a[8:9], v12 offset:45760
  ds_read_b64_tr_b16 a[10:11], v12 offset:46784
  v_mfma_f32_16x16x32_bf16 v[52:55], a[12:15], v[128:131], v[52:55]
  buffer_load_dwordx4 v0, s[68:71], s87 offen offset:3264 lds
  v_rcp_f32 v96, v96
  v_rcp_f32 v97, v97
  v_mul_f32 v112, v112, v96
  v_mul_f32 v113, v113, v97
  v_cvt_pk_bf16_f32 v96, v112, v113
  v_mfma_f32_16x16x32_bf16 v[32:35], a[16:19], v[144:147], v[32:35]
  ds_read_b64_tr_b16 a[12:13], v7 offset:45760
  ds_read_b64_tr_b16 a[14:15], v7 offset:46784
  v_mfma_f32_16x16x32_bf16 v[40:43], a[16:19], v[148:151], v[40:43]
  s_add_u32 m0, s28, 17408
  v_mul_f32 v18, v98, v98
  v_mul_f32 v19, v99, v99
  v_mul_f32 v114, v98, v114
  v_mul_f32 v115, v99, v115
  v_fma_f32 v18, v18, v20, v25
  v_fma_f32 v19, v19, v20, v25
  v_add_u32_e64 v0, s43, v3
  v_mfma_f32_16x16x32_bf16 v[44:47], a[20:23], v[148:151], v[44:47]
  buffer_load_dwordx4 v0, s[68:71], 0 offen lds
  ds_read_b64_tr_b16 a[16:17], v12 offset:39488
  v_mfma_f32_16x16x32_bf16 v[36:39], a[20:23], v[144:147], v[36:39]
  ds_read_b64_tr_b16 a[18:19], v12 offset:40512
  buffer_load_dwordx4 v0, s[68:71], s86 offen offset:1088 lds
  v_mul_f32 v98, v98, v18
  v_mul_f32 v99, v99, v19
  v_exp_f32 v98, v98
  v_exp_f32 v99, v99
  v_fma_f32 v98, v98, v27, v27
  v_mfma_f32_16x16x32_bf16 v[48:51], a[24:27], v[144:147], v[48:51]
  ds_read_b64_tr_b16 a[20:21], v7 offset:39488
  ds_read_b64_tr_b16 a[22:23], v7 offset:40512
  v_mfma_f32_16x16x32_bf16 v[56:59], a[24:27], v[148:151], v[56:59]
  buffer_load_dwordx4 v0, s[68:71], s84 offen offset:2176 lds
  v_fma_f32 v99, v99, v27, v27
  v_rcp_f32 v98, v98
  v_rcp_f32 v99, v99
  v_mul_f32 v114, v114, v98
  v_mul_f32_e64 v115, v115, v99
  v_mfma_f32_16x16x32_bf16 v[60:63], a[28:31], v[148:151], v[60:63]
  s_waitcnt lgkmcnt(4)
  ds_read_b64_tr_b16 a[24:25], v12 offset:47808
  ds_read_b64_tr_b16 a[26:27], v12 offset:48832
  v_mfma_f32_16x16x32_bf16 v[52:55], a[28:31], v[144:147], v[52:55]
  buffer_load_dwordx4 v0, s[68:71], s87 offen offset:3264 lds
  v_cvt_pk_bf16_f32 v97, v114, v115
  v_mul_f32 v18, v100, v100
  v_mul_f32 v19, v101, v101
  v_mul_f32 v116, v100, v116
  v_mul_f32 v117, v101, v117
  v_fma_f32 v18, v18, v20, v25
  v_fma_f32 v19, v19, v20, v25
  v_mfma_f32_16x16x32_bf16 v[32:35], a[0:3], v[160:163], v[32:35]
  ds_read_b64_tr_b16 a[28:29], v7 offset:47808
  ds_read_b64_tr_b16 a[30:31], v7 offset:48832
  v_mfma_f32_16x16x32_bf16 v[40:43], a[0:3], v[164:167], v[40:43]
  v_mul_f32 v100, v100, v18
  v_mul_f32 v101, v101, v19
  v_exp_f32 v100, v100
  v_exp_f32 v101, v101
  v_mfma_f32_16x16x32_bf16 v[44:47], a[4:7], v[164:167], v[44:47]
  s_waitcnt vmcnt(19)
  s_barrier
  ds_read_b64_tr_b16 a[0:1], v12 offset:49920
  ds_read_b64_tr_b16 a[2:3], v12 offset:50944
  v_mfma_f32_16x16x32_bf16 v[36:39], a[4:7], v[160:163], v[36:39]
  v_fma_f32 v100, v100, v27, v27
  v_fma_f32 v101, v101, v27, v27
  v_rcp_f32 v100, v100
  v_rcp_f32 v101, v101
  v_mul_f32_e64 v116, v116, v100
  v_mfma_f32_16x16x32_bf16 v[48:51], a[8:11], v[160:163], v[48:51]
  ds_read_b64_tr_b16 a[4:5], v7 offset:49920
  ds_read_b64_tr_b16 a[6:7], v7 offset:50944
  v_mfma_f32_16x16x32_bf16 v[56:59], a[8:11], v[164:167], v[56:59]
  v_mul_f32 v117, v117, v101
  v_cvt_pk_bf16_f32 v98, v116, v117
  v_mul_f32 v18, v102, v102
  v_mul_f32_e64 v19, v103, v103
  v_mul_f32_e64 v118, v102, v118
  v_mul_f32 v119, v103, v119
  v_fma_f32 v18, v18, v20, v25
  v_mfma_f32_16x16x32_bf16 v[60:63], a[12:15], v[164:167], v[60:63]
  s_waitcnt lgkmcnt(4)
  ds_read_b64_tr_b16 a[8:9], v12 offset:58240
  ds_read_b64_tr_b16 a[10:11], v12 offset:59264
  v_mfma_f32_16x16x32_bf16 v[52:55], a[12:15], v[160:163], v[52:55]
Lpad5:
  s_cbranch_execz Lret5
  v_fma_f32 v19, v19, v20, v25
  v_mul_f32 v102, v102, v18
  v_mul_f32 v103, v103, v19
  v_exp_f32 v102, v102
  v_exp_f32_e64 v103, v103
  v_mfma_f32_16x16x32_bf16 v[32:35], a[16:19], v[176:179], v[32:35]
  ds_read_b64_tr_b16 a[12:13], v7 offset:58240
  ds_read_b64_tr_b16 a[14:15], v7 offset:59264
  v_mfma_f32_16x16x32_bf16 v[40:43], a[16:19], v[180:183], v[40:43]
  v_fma_f32 v102, v102, v27, v27
  v_fma_f32 v103, v103, v27, v27
  v_rcp_f32_e64 v102, v102
  v_rcp_f32_e64 v103, v103
  v_mfma_f32_16x16x32_bf16 v[44:47], a[20:23], v[180:183], v[44:47]
  s_add_u32 s31, s47, 1572864
  ds_read_b64_tr_b16 a[16:17], v12 offset:51968
  ds_read_b64_tr_b16 a[18:19], v12 offset:52992
  v_mfma_f32_16x16x32_bf16 v[36:39], a[20:23], v[176:179], v[36:39]
  v_mul_f32_e64 v118, v118, v102
  v_mul_f32_e64 v119, v119, v103
  v_cvt_pk_bf16_f32 v99, v118, v119
  v_mul_f32_e64 v18, v104, v104
  v_mul_f32_e64 v19, v105, v105
  v_mul_f32_e64 v120, v104, v120
  v_mul_f32_e64 v121, v105, v121
  v_mfma_f32_16x16x32_bf16 v[48:51], a[24:27], v[176:179], v[48:51]
  buffer_store_dwordx4 v[96:99], v28, s[72:75], s31 offen sc1
  ds_read_b64_tr_b16 a[20:21], v7 offset:51968
  v_mfma_f32_16x16x32_bf16 v[56:59], a[24:27], v[180:183], v[56:59]
  ds_read_b64_tr_b16 a[22:23], v7 offset:52992
  v_fma_f32 v18, v18, v21, v26
  v_fma_f32 v19, v19, v21, v26
  v_mul_f32_e64 v104, v104, v18
  v_mul_f32_e64 v105, v105, v19
  v_exp_f32_e64 v104, v104
  v_exp_f32 v105, v105
  v_mfma_f32_16x16x32_bf16 v[60:63], a[28:31], v[180:183], v[60:63]
  s_waitcnt vmcnt(10) lgkmcnt(4)
  ds_read_b64_tr_b16 a[24:25], v12 offset:60288
  ds_read_b64_tr_b16 a[26:27], v12 offset:61312
  v_mfma_f32_16x16x32_bf16 v[52:55], a[28:31], v[176:179], v[52:55]
  v_fma_f32 v104, v104, v14, v14
  v_fma_f32 v105, v105, v14, v14
  v_rcp_f32_e64 v104, v104
  v_rcp_f32 v105, v105
  s_mov_b64 exec, 0xff
  buffer_store_dwordx4 v[28:31], v1, s[72:75], s95 offen offset:1024 sc1
  s_mov_b64 exec, -1
  v_mfma_f32_16x16x32_bf16 v[32:35], a[0:3], v[192:195], v[32:35]
  ds_read_b64_tr_b16 a[28:29], v7 offset:60288
  ds_read_b64_tr_b16 a[30:31], v7 offset:61312
  v_mfma_f32_16x16x32_bf16 v[40:43], a[0:3], v[196:199], v[40:43]
  v_mul_f32 v120, v120, v104
  v_mul_f32 v121, v121, v105
  v_cvt_pk_bf16_f32 v104, v120, v121
  v_mul_f32 v18, v106, v106
  v_mul_f32 v19, v107, v107
  v_mul_f32_e64 v122, v106, v122
  v_mfma_f32_16x16x32_bf16 v[44:47], a[4:7], v[196:199], v[44:47]
  ds_read_b64_tr_b16 a[0:1], v12 offset:54080
  ds_read_b64_tr_b16 a[2:3], v12 offset:55104
  v_mfma_f32_16x16x32_bf16 v[36:39], a[4:7], v[192:195], v[36:39]
  v_mul_f32_e64 v123, v107, v123
  v_fma_f32 v18, v18, v21, v26
  v_fma_f32 v19, v19, v21, v26
  v_mul_f32_e64 v106, v106, v18
  v_mul_f32_e64 v107, v107, v19
  v_exp_f32 v106, v106
  v_mfma_f32_16x16x32_bf16 v[48:51], a[8:11], v[192:195], v[48:51]
  s_waitcnt vmcnt(10)
  ds_read_b64_tr_b16 a[4:5], v7 offset:54080
  ds_read_b64_tr_b16 a[6:7], v7 offset:55104
  v_mfma_f32_16x16x32_bf16 v[56:59], a[8:11], v[196:199], v[56:59]
  v_exp_f32 v107, v107
  v_fma_f32 v106, v106, v14, v14
  v_fma_f32 v107, v107, v14, v14
  v_rcp_f32 v106, v106
  v_cmp_ne_u32 s[0:1], s10, v24
  s_nop 0
  s_and_b32 s0, s0, 0xff
  s_cbranch_scc1 Lfl0_slow
Lfl0_back:
  v_mfma_f32_16x16x32_bf16 v[60:63], a[12:15], v[196:199], v[60:63]
  s_waitcnt lgkmcnt(4)
  s_mul_i32 s97, s4, 262144
  s_add_u32 s97, s97, s101
  buffer_load_dwordx4 v[136:139], v28, s[72:75], s97 offen sc1
  buffer_load_dwordx4 v[140:143], v29, s[72:75], s97 offen sc1
  v_mfma_f32_16x16x32_bf16 v[52:55], a[12:15], v[192:195], v[52:55]
  ds_read_b64_tr_b16 a[8:9], v12 offset:62400
  ds_read_b64_tr_b16 a[10:11], v12 offset:63424
  s_add_u32 s97, s97, 16384
  buffer_load_dwordx4 v[152:155], v28, s[72:75], s97 offen sc1
  v_rcp_f32 v107, v107
  v_mul_f32 v122, v122, v106
  v_mul_f32 v123, v123, v107
  v_cvt_pk_bf16_f32 v105, v122, v123
  v_mul_f32 v18, v108, v108
  v_mul_f32_e64 v19, v109, v109
  v_mfma_f32_16x16x32_bf16 v[32:35], a[16:19], v[208:211], v[32:35]
  ds_read_b64_tr_b16 a[12:13], v7 offset:62400
  ds_read_b64_tr_b16 a[14:15], v7 offset:63424
  v_mfma_f32_16x16x32_bf16 v[40:43], a[16:19], v[212:215], v[40:43]
  buffer_load_dwordx4 v[156:159], v29, s[72:75], s97 offen sc1
  v_mul_f32 v124, v108, v124
  v_mul_f32 v125, v109, v125
  v_fma_f32 v18, v18, v21, v26
  v_fma_f32 v19, v19, v21, v26
  v_mul_f32 v108, v108, v18
  v_mul_f32 v109, v109, v19
  v_exp_f32_e64 v108, v108
  v_mfma_f32_16x16x32_bf16 v[44:47], a[20:23], v[212:215], v[44:47]
  s_add_u32 s97, s97, 16384
  ds_read_b64_tr_b16 a[16:17], v12 offset:56128
  ds_read_b64_tr_b16 a[18:19], v12 offset:57152
  v_mfma_f32_16x16x32_bf16 v[36:39], a[20:23], v[208:211], v[36:39]
  buffer_load_dwordx4 v[168:171], v28, s[72:75], s97 offen sc1
  v_exp_f32 v109, v109
  v_fma_f32 v108, v108, v14, v14
  v_fma_f32 v109, v109, v14, v14
  v_rcp_f32 v108, v108
  v_mfma_f32_16x16x32_bf16 v[48:51], a[24:27], v[208:211], v[48:51]
  ds_read_b64_tr_b16 a[20:21], v7 offset:56128
  ds_read_b64_tr_b16 a[22:23], v7 offset:57152
  v_mfma_f32_16x16x32_bf16 v[56:59], a[24:27], v[212:215], v[56:59]
  buffer_load_dwordx4 v[172:175], v29, s[72:75], s97 offen sc1
  v_rcp_f32 v109, v109
  v_mul_f32 v124, v124, v108
  v_mul_f32_e64 v125, v125, v109
  v_cvt_pk_bf16_f32 v106, v124, v125
  v_mul_f32 v18, v110, v110
  v_mfma_f32_16x16x32_bf16 v[60:63], a[28:31], v[212:215], v[60:63]
  s_waitcnt lgkmcnt(4)
  ds_read_b64_tr_b16 a[24:25], v12 offset:64448
  ds_read_b64_tr_b16 a[26:27], v12 offset:65472
  v_mfma_f32_16x16x32_bf16 v[52:55], a[28:31], v[208:211], v[52:55]
  s_add_u32 s97, s97, 16384
  buffer_load_dwordx4 v[184:187], v28, s[72:75], s97 offen sc1
  v_mul_f32 v19, v111, v111
  v_mul_f32 v126, v110, v126
  v_mul_f32 v127, v111, v127
  v_fma_f32 v18, v18, v21, v26
  v_fma_f32 v19, v19, v21, v26
  v_mul_f32 v110, v110, v18
  v_mul_f32_e64 v111, v111, v19
  v_mfma_f32_16x16x32_bf16 v[32:35], a[0:3], v[224:227], v[32:35]
  ds_read_b64_tr_b16 a[28:29], v7 offset:64448
  ds_read_b64_tr_b16 a[30:31], v7 offset:65472
  v_mfma_f32_16x16x32_bf16 v[40:43], a[0:3], v[228:231], v[40:43]
  buffer_load_dwordx4 v[188:191], v29, s[72:75], s97 offen sc1
  v_exp_f32 v110, v110
  v_exp_f32 v111, v111
  v_fma_f32 v110, v110, v14, v14
  v_fma_f32 v111, v111, v14, v14
  v_rcp_f32 v110, v110
  v_mfma_f32_16x16x32_bf16 v[44:47], a[4:7], v[228:231], v[44:47]
  v_rcp_f32 v111, v111
  v_mfma_f32_16x16x32_bf16 v[36:39], a[4:7], v[224:227], v[36:39]
  v_mul_f32_e64 v126, v126, v110
  v_mul_f32 v127, v127, v111
  v_cvt_pk_bf16_f32 v107, v126, v127
  v_mfma_f32_16x16x32_bf16 v[48:51], a[8:11], v[224:227], v[48:51]
  buffer_store_dwordx4 v[104:107], v29, s[72:75], s31 offen sc1
  v_mfma_f32_16x16x32_bf16 v[56:59], a[8:11], v[228:231], v[56:59]
  v_mfma_f32_16x16x32_bf16 v[60:63], a[12:15], v[228:231], v[60:63]
  s_waitcnt lgkmcnt(0)
  v_mfma_f32_16x16x32_bf16 v[52:55], a[12:15], v[224:227], v[52:55]
  v_mfma_f32_16x16x32_bf16 v[32:35], a[16:19], v[240:243], v[32:35]
  v_mfma_f32_16x16x32_bf16 v[40:43], a[16:19], v[244:247], v[40:43]
  v_mfma_f32_16x16x32_bf16 v[44:47], a[20:23], v[244:247], v[44:47]
  v_mfma_f32_16x16x32_bf16 v[36:39], a[20:23], v[240:243], v[36:39]
  v_mfma_f32_16x16x32_bf16 v[48:51], a[24:27], v[240:243], v[48:51]
  v_mfma_f32_16x16x32_bf16 v[56:59], a[24:27], v[244:247], v[56:59]
  v_mfma_f32_16x16x32_bf16 v[60:63], a[28:31], v[244:247], v[60:63]
  s_add_u32 s97, s97, 16384
  buffer_load_dwordx4 v[200:203], v28, s[72:75], s97 offen sc1
  buffer_load_dwordx4 v[204:207], v29, s[72:75], s97 offen sc1
  v_mfma_f32_16x16x32_bf16 v[52:55], a[28:31], v[240:243], v[52:55]
  s_waitcnt vmcnt(9)
  v_mfma_f32_16x16x32_bf16 v[64:67], v[136:139], a[64:67], 0
  s_nop 0
  ds_read_b64_tr_b16 a[0:1], v8 offset:34816
  ds_read_b64_tr_b16 a[4:5], v9 offset:34816
  v_mfma_f32_16x16x32_bf16 v[80:83], v[140:143], a[64:67], 0
  s_add_u32 s97, s97, 16384
  buffer_load_dwordx4 v[216:219], v28, s[72:75], s97 offen sc1
  buffer_load_dwordx4 v[220:223], v29, s[72:75], s97 offen sc1
  v_mfma_f32_16x16x32_bf16 v[84:87], v[140:143], a[68:71], 0
  s_add_u32 s97, s97, 16384
  ds_read_b64_tr_b16 a[8:9], v8 offset:34880
  ds_read_b64_tr_b16 a[12:13], v9 offset:34880
  v_mfma_f32_16x16x32_bf16 v[68:71], v[136:139], a[68:71], 0
  buffer_load_dwordx4 v[232:235], v28, s[72:75], s97 offen sc1
  v_mul_f32 v18, v32, v32
  v_mul_f32 v19, v33, v33
  v_mul_f32 v48, v32, v48
  v_mul_f32 v49, v33, v49
  v_fma_f32 v18, v18, v20, v25
  v_fma_f32 v19, v19, v20, v25
  v_mul_f32 v32, v32, v18
  v_mul_f32 v33, v33, v19
  v_exp_f32 v32, v32
  v_exp_f32 v33, v33
  v_fma_f32 v32, v32, v27, v27
  v_fma_f32 v33, v33, v27, v27
  v_mfma_f32_16x16x32_bf16 v[72:75], v[136:139], a[80:83], 0
  ds_read_b64_tr_b16 a[2:3], v8 offset:36992
  ds_read_b64_tr_b16 a[6:7], v9 offset:36992
  v_mfma_f32_16x16x32_bf16 v[88:91], v[140:143], a[80:83], 0
  buffer_load_dwordx4 v[236:239], v29, s[72:75], s97 offen sc1
  s_add_u32 s97, s97, 16384
  buffer_load_dwordx4 v[248:251], v28, s[72:75], s97 offen sc1
  v_rcp_f32 v32, v32
  v_rcp_f32 v33, v33
  v_mul_f32 v48, v48, v32
  v_mul_f32 v49, v49, v33
  v_cvt_pk_bf16_f32 v32, v48, v49
  v_mul_f32 v18, v34, v34
  v_mul_f32 v19, v35, v35
  v_mul_f32 v50, v34, v50
  v_mul_f32 v51, v35, v51
  v_fma_f32 v18, v18, v20, v25
  v_fma_f32 v19, v19, v20, v25
  v_mul_f32_e64 v34, v34, v18
  v_mfma_f32_16x16x32_bf16 v[92:95], v[140:143], a[84:87], 0
  ds_read_b64_tr_b16 a[10:11], v8 offset:37056
  ds_read_b64_tr_b16 a[14:15], v9 offset:37056
  v_mfma_f32_16x16x32_bf16 v[76:79], v[136:139], a[84:87], 0
  buffer_load_dwordx4 v[252:255], v29, s[72:75], s97 offen sc1
  s_waitcnt vmcnt(13)
  v_mul_f32 v35, v35, v19
  v_exp_f32_e64 v34, v34
  v_exp_f32_e64 v35, v35
  v_fma_f32 v34, v34, v27, v27
  v_fma_f32 v35, v35, v27, v27
  v_rcp_f32_e64 v34, v34
  v_rcp_f32_e64 v35, v35
  v_mul_f32_e64 v50, v50, v34
  v_mul_f32 v51, v51, v35
  v_cvt_pk_bf16_f32 v33, v50, v51
  v_mfma_f32_16x16x32_bf16 v[96:99], v[152:155], a[64:67], 0
  s_add_u32 s97, s97, 16384
  s_barrier
  ds_read_b64_tr_b16 a[16:17], v8 offset:52224
  ds_read_b64_tr_b16 a[20:21], v9 offset:52224
  v_mfma_f32_16x16x32_bf16 v[112:115], v[156:159], a[64:67], 0
  buffer_load_dwordx4 v[128:131], v28, s[72:75], s97 offen sc1
  buffer_load_dwordx4 v[132:135], v29, s[72:75], s97 offen sc1
  v_mul_f32 v18, v36, v36
  v_mul_f32 v19, v37, v37
  v_mul_f32 v52, v36, v52
  v_mul_f32 v53, v37, v53
  v_fma_f32 v18, v18, v20, v25
  v_fma_f32 v19, v19, v20, v25
  v_mul_f32_e64 v36, v36, v18
  v_mul_f32_e64 v37, v37, v19
  v_exp_f32_e64 v36, v36
  v_exp_f32 v37, v37
  v_fma_f32 v36, v36, v27, v27
  v_fma_f32 v37, v37, v27, v27
  v_mfma_f32_16x16x32_bf16 v[116:119], v[156:159], a[68:71], 0
  s_waitcnt vmcnt(10)
  ds_read_b64_tr_b16 a[24:25], v8 offset:52288
  ds_read_b64_tr_b16 a[28:29], v9 offset:52288
  v_mfma_f32_16x16x32_bf16 v[100:103], v[152:155], a[68:71], 0
  v_rcp_f32 v36, v36
  v_rcp_f32 v37, v37
  v_mul_f32 v52, v52, v36
  v_mul_f32 v53, v53, v37
  v_cvt_pk_bf16_f32 v34, v52, v53
  v_mul_f32_e64 v18, v38, v38
  v_mul_f32_e64 v19, v39, v39
  v_mul_f32_e64 v54, v38, v54
  v_mul_f32_e64 v55, v39, v55
  v_fma_f32 v18, v18, v20, v25
  v_fma_f32 v19, v19, v20, v25
  v_mul_f32 v38, v38, v18
  s_mov_b64 exec, 0xff
  buffer_store_dwordx4 v[28:31], v1, s[72:75], s95 offen offset:2048 sc1
  s_mov_b64 exec, -1
  v_mfma_f32_16x16x32_bf16 v[104:107], v[152:155], a[80:83], 0
  s_add_u32 s97, s97, 16384
  buffer_load_dwordx4 v[144:147], v28, s[72:75], s97 offen sc1
  ds_read_b64_tr_b16 a[18:19], v8 offset:54400
  v_mfma_f32_16x16x32_bf16 v[120:123], v[156:159], a[80:83], 0
  ds_read_b64_tr_b16 a[22:23], v9 offset:54400
  buffer_load_dwordx4 v[148:151], v29, s[72:75], s97 offen sc1
  v_mul_f32 v39, v39, v19
  v_exp_f32 v38, v38
  v_exp_f32_e64 v39, v39
  v_fma_f32 v38, v38, v27, v27
  v_fma_f32 v39, v39, v27, v27
  v_rcp_f32 v38, v38
  v_rcp_f32 v39, v39
  v_mul_f32 v54, v54, v38
  v_mul_f32 v55, v55, v39
  v_cvt_pk_bf16_f32 v35, v54, v55
  v_mfma_f32_16x16x32_bf16 v[124:127], v[156:159], a[84:87], 0
  s_add_u32 s97, s97, 16384
  ds_read_b64_tr_b16 a[26:27], v8 offset:54464
  ds_read_b64_tr_b16 a[30:31], v9 offset:54464
  v_mfma_f32_16x16x32_bf16 v[108:111], v[152:155], a[84:87], 0
  buffer_load_dwordx4 v[160:163], v28, s[72:75], s97 offen sc1
  buffer_load_dwordx4 v[164:167], v29, s[72:75], s97 offen sc1
  v_mul_f32 v18, v40, v40
  v_mul_f32 v19, v41, v41
  v_mul_f32 v56, v40, v56
  v_mul_f32 v57, v41, v57
  v_fma_f32 v18, v18, v21, v26
  v_fma_f32 v19, v19, v21, v26
  v_mul_f32 v40, v40, v18
  v_mul_f32 v41, v41, v19
  v_exp_f32 v40, v40
  v_exp_f32 v41, v41
  v_fma_f32 v40, v40, v14, v14
  v_fma_f32 v41, v41, v14, v14
  v_mfma_f32_16x16x32_bf16 v[64:67], v[168:171], a[96:99], v[64:67]
  s_add_u32 s97, s97, 16384
  buffer_load_dwordx4 v[176:179], v28, s[72:75], s97 offen sc1
  v_rcp_f32_e64 v40, v40
  v_mfma_f32_16x16x32_bf16 v[80:83], v[172:175], a[96:99], v[80:83]
  v_rcp_f32 v41, v41
  v_mul_f32 v56, v56, v40
  v_mul_f32 v57, v57, v41
  v_cvt_pk_bf16_f32 v40, v56, v57
  v_mul_f32 v18, v42, v42
  v_mul_f32 v19, v43, v43
  v_mul_f32 v58, v42, v58
  v_mul_f32 v59, v43, v59
  v_fma_f32 v18, v18, v21, v26
  v_fma_f32 v19, v19, v21, v26
  v_mul_f32 v42, v42, v18
  v_mfma_f32_16x16x32_bf16 v[84:87], v[172:175], a[100:103], v[84:87]
  buffer_load_dwordx4 v[180:183], v29, s[72:75], s97 offen sc1
  v_mul_f32 v43, v43, v19
  v_mfma_f32_16x16x32_bf16 v[68:71], v[168:171], a[100:103], v[68:71]
  v_exp_f32 v42, v42
  v_exp_f32 v43, v43
  v_fma_f32 v42, v42, v14, v14
  v_fma_f32 v43, v43, v14, v14
  v_rcp_f32 v42, v42
  v_rcp_f32 v43, v43
  v_mul_f32 v58, v58, v42
  v_mul_f32 v59, v59, v43
  v_cvt_pk_bf16_f32 v41, v58, v59
  v_mfma_f32_16x16x32_bf16 v[72:75], v[168:171], a[112:115], v[72:75]
  v_mul_f32 v18, v44, v44
  v_mul_f32_e64 v19, v45, v45
  v_mfma_f32_16x16x32_bf16 v[88:91], v[172:175], a[112:115], v[88:91]
  v_mul_f32 v60, v44, v60
  v_mul_f32 v61, v45, v61
  v_fma_f32 v18, v18, v21, v26
  v_fma_f32 v19, v19, v21, v26
  v_mul_f32 v44, v44, v18
  v_mul_f32 v45, v45, v19
  v_exp_f32 v44, v44
  v_exp_f32 v45, v45
  v_fma_f32 v44, v44, v14, v14
  v_fma_f32 v45, v45, v14, v14
  v_lshlrev_b32 v24, 3, v1
  s_mov_b64 exec, 0xff
  buffer_load_dword v24, v24, s[72:75], s98 offen offset:1036 sc1
  s_mov_b64 exec, -1
  v_mfma_f32_16x16x32_bf16 v[92:95], v[172:175], a[116:119], v[92:95]
  s_add_u32 s97, s97, 16384
  buffer_load_dwordx4 v[192:195], v28, s[72:75], s97 offen sc1
  buffer_load_dwordx4 v[196:199], v29, s[72:75], s97 offen sc1
  v_mfma_f32_16x16x32_bf16 v[76:79], v[168:171], a[116:119], v[76:79]
  v_rcp_f32 v44, v44
  v_rcp_f32 v45, v45
  v_mul_f32 v60, v60, v44
  v_mul_f32 v61, v61, v45
  v_cvt_pk_bf16_f32 v42, v60, v61
  v_mul_f32 v18, v46, v46
  v_mul_f32 v19, v47, v47
  v_mul_f32 v62, v46, v62
  v_mul_f32 v63, v47, v63
  v_fma_f32 v18, v18, v21, v26
  v_fma_f32 v19, v19, v21, v26
  v_mul_f32_e64 v46, v46, v18
  v_mfma_f32_16x16x32_bf16 v[96:99], v[184:187], a[96:99], v[96:99]
  s_add_u32 s31, s94, 2097152
  buffer_store_dwordx4 v[32:35], v28, s[72:75], s31 offen sc1
  v_mul_f32_e64 v47, v47, v19
  v_mfma_f32_16x16x32_bf16 v[112:115], v[188:191], a[96:99], v[112:115]
  v_exp_f32 v46, v46
  v_exp_f32 v47, v47
  v_fma_f32 v46, v46, v14, v14
  v_fma_f32 v47, v47, v14, v14
  v_rcp_f32 v46, v46
  v_rcp_f32 v47, v47
  v_mul_f32 v62, v62, v46
  v_mul_f32 v63, v63, v47
  v_cvt_pk_bf16_f32 v43, v62, v63
  v_mfma_f32_16x16x32_bf16 v[116:119], v[188:191], a[100:103], v[116:119]
  v_mfma_f32_16x16x32_bf16 v[100:103], v[184:187], a[100:103], v[100:103]
  v_mfma_f32_16x16x32_bf16 v[104:107], v[184:187], a[112:115], v[104:107]
  v_mfma_f32_16x16x32_bf16 v[120:123], v[188:191], a[112:115], v[120:123]
  v_mfma_f32_16x16x32_bf16 v[124:127], v[188:191], a[116:119], v[124:127]
  s_waitcnt vmcnt(19)
  v_mfma_f32_16x16x32_bf16 v[108:111], v[184:187], a[116:119], v[108:111]
  v_mfma_f32_16x16x32_bf16 v[64:67], v[200:203], a[72:75], v[64:67]
  v_mfma_f32_16x16x32_bf16 v[80:83], v[204:207], a[72:75], v[80:83]
  v_mfma_f32_16x16x32_bf16 v[84:87], v[204:207], a[76:79], v[84:87]
  v_mfma_f32_16x16x32_bf16 v[68:71], v[200:203], a[76:79], v[68:71]
  v_mfma_f32_16x16x32_bf16 v[72:75], v[200:203], a[88:91], v[72:75]
  buffer_store_dwordx4 v[40:43], v29, s[72:75], s31 offen sc1
  v_mfma_f32_16x16x32_bf16 v[88:91], v[204:207], a[88:91], v[88:91]
  v_mfma_f32_16x16x32_bf16 v[92:95], v[204:207], a[92:95], v[92:95]
  s_waitcnt vmcnt(18)
  v_mfma_f32_16x16x32_bf16 v[76:79], v[200:203], a[92:95], v[76:79]
  v_mfma_f32_16x16x32_bf16 v[96:99], v[216:219], a[72:75], v[96:99]
  v_mfma_f32_16x16x32_bf16 v[112:115], v[220:223], a[72:75], v[112:115]
  v_mfma_f32_16x16x32_bf16 v[116:119], v[220:223], a[76:79], v[116:119]
  v_mfma_f32_16x16x32_bf16 v[100:103], v[216:219], a[76:79], v[100:103]
  v_mfma_f32_16x16x32_bf16 v[104:107], v[216:219], a[88:91], v[104:107]
  v_mfma_f32_16x16x32_bf16 v[120:123], v[220:223], a[88:91], v[120:123]
  v_mfma_f32_16x16x32_bf16 v[124:127], v[220:223], a[92:95], v[124:127]
  s_add_u32 s97, s97, 16384
  buffer_load_dwordx4 v[208:211], v28, s[72:75], s97 offen sc1
  s_waitcnt vmcnt(17)
  v_mfma_f32_16x16x32_bf16 v[108:111], v[216:219], a[92:95], v[108:111]
  v_mfma_f32_16x16x32_bf16 v[64:67], v[232:235], a[104:107], v[64:67]
  v_mfma_f32_16x16x32_bf16 v[80:83], v[236:239], a[104:107], v[80:83]
  v_mfma_f32_16x16x32_bf16 v[84:87], v[236:239], a[108:111], v[84:87]
  buffer_load_dwordx4 v[212:215], v29, s[72:75], s97 offen sc1
  v_mfma_f32_16x16x32_bf16 v[68:71], v[232:235], a[108:111], v[68:71]
  v_mfma_f32_16x16x32_bf16 v[72:75], v[232:235], a[120:123], v[72:75]
  s_lshl_b32 s3, s7, 6
  s_lshl1_add_u32 s11, s4, s3
  v_lshrrev_b32 v25, 8, v1
  v_lshl_add_u32 v27, v25, 3, s11
  v_mfma_f32_16x16x32_bf16 v[88:91], v[236:239], a[120:123], v[88:91]
  v_and_b32 v4, 0xf0, v1
  s_lshl_b32 s11, s8, 8
  v_add_u32 v4, s11, v4
  v_lshl_add_u32 v14, v27, 11, v4
  v_lshrrev_b32 v15, 1, v14
  v_lshrrev_b32 v4, 1, v4
  v_mfma_f32_16x16x32_bf16 v[92:95], v[236:239], a[124:127], v[92:95]
  s_mov_b32 s18, 32768
  s_mov_b32 s20, 65536
  s_add_u32 s97, s97, 16384
  buffer_load_dwordx4 v[224:227], v28, s[72:75], s97 offen sc1
  s_waitcnt vmcnt(17)
  v_mfma_f32_16x16x32_bf16 v[76:79], v[232:235], a[124:127], v[76:79]
  v_mfma_f32_16x16x32_bf16 v[96:99], v[248:251], a[104:107], v[96:99]
  buffer_load_dwordx2 v[48:49], v15, s[48:51], 0 offen offset:0
  s_nop 0
  v_mfma_f32_16x16x32_bf16 v[112:115], v[252:255], a[104:107], v[112:115]
  v_mfma_f32_16x16x32_bf16 v[116:119], v[252:255], a[108:111], v[116:119]
  buffer_load_dwordx4 v[228:231], v29, s[72:75], s97 offen sc1
  v_mfma_f32_16x16x32_bf16 v[100:103], v[248:251], a[108:111], v[100:103]
  v_mfma_f32_16x16x32_bf16 v[104:107], v[248:251], a[120:123], v[104:107]
  v_mfma_f32_16x16x32_bf16 v[120:123], v[252:255], a[120:123], v[120:123]
  v_mfma_f32_16x16x32_bf16 v[124:127], v[252:255], a[124:127], v[124:127]
  buffer_load_dwordx2 v[50:51], v15, s[48:51], 0 offen offset:1024
  s_waitcnt vmcnt(18)
  v_mfma_f32_16x16x32_bf16 v[108:111], v[248:251], a[124:127], v[108:111]
  v_mfma_f32_16x16x32_bf16 v[64:67], v[128:131], a[128:131], v[64:67]
  ds_read_b64_tr_b16 a[64:65], v8 offset:0
  s_nop 0
  ds_read_b64_tr_b16 a[68:69], v9 offset:0
  v_mfma_f32_16x16x32_bf16 v[80:83], v[132:135], a[128:131], v[80:83]
  s_add_u32 s97, s97, 16384
  buffer_load_dwordx4 v[240:243], v28, s[72:75], s97 offen sc1
  v_mfma_f32_16x16x32_bf16 v[84:87], v[132:135], a[132:135], v[84:87]
  ds_read_b64_tr_b16 a[72:73], v8 offset:64
  ds_read_b64_tr_b16 a[76:77], v9 offset:64
  v_mfma_f32_16x16x32_bf16 v[68:71], v[128:131], a[132:135], v[68:71]
  v_mfma_f32_16x16x32_bf16 v[72:75], v[128:131], a[144:147], v[72:75]
  buffer_load_dwordx2 v[52:53], v15, s[48:51], s18 offen offset:0
  ds_read_b64_tr_b16 a[66:67], v8 offset:2176
  v_mfma_f32_16x16x32_bf16 v[88:91], v[132:135], a[144:147], v[88:91]
  ds_read_b64_tr_b16 a[70:71], v9 offset:2176
  v_mfma_f32_16x16x32_bf16 v[92:95], v[132:135], a[148:151], v[92:95]
  ds_read_b64_tr_b16 a[74:75], v8 offset:2240
  ds_read_b64_tr_b16 a[78:79], v9 offset:2240
  v_mfma_f32_16x16x32_bf16 v[76:79], v[128:131], a[148:151], v[76:79]
  buffer_load_dwordx4 v[244:247], v29, s[72:75], s97 offen sc1
  s_waitcnt vmcnt(18)
  v_mfma_f32_16x16x32_bf16 v[96:99], v[144:147], a[128:131], v[96:99]
  ds_read_b64_tr_b16 a[80:81], v8 offset:17408
  ds_read_b64_tr_b16 a[84:85], v9 offset:17408
  v_mfma_f32_16x16x32_bf16 v[112:115], v[148:151], a[128:131], v[112:115]
  v_mfma_f32_16x16x32_bf16 v[116:119], v[148:151], a[132:135], v[116:119]
  s_waitcnt vmcnt(13)
  ds_read_b64_tr_b16 a[88:89], v8 offset:17472
  ds_read_b64_tr_b16 a[92:93], v9 offset:17472
  v_mfma_f32_16x16x32_bf16 v[100:103], v[144:147], a[132:135], v[100:103]
  v_cmp_ne_u32 s[0:1], s10, v24
  s_nop 0
  s_and_b32 s0, s0, 0xff
  s_cbranch_scc1 Lfl1_slow
Lfl1_back:
  v_mfma_f32_16x16x32_bf16 v[104:107], v[144:147], a[144:147], v[104:107]
  s_mul_i32 s97, s4, 131072
  s_add_u32 s97, s97, s101
  s_add_u32 s97, s97, 1048576
  buffer_load_dwordx4 v[136:139], v28, s[72:75], s97 offen sc1
  buffer_load_dwordx2 v[54:55], v15, s[48:51], s18 offen offset:1024
  s_nop 0
  v_mfma_f32_16x16x32_bf16 v[120:123], v[148:151], a[144:147], v[120:123]
  ds_read_b64_tr_b16 a[82:83], v8 offset:19584
  ds_read_b64_tr_b16 a[86:87], v9 offset:19584
  v_mfma_f32_16x16x32_bf16 v[124:127], v[148:151], a[148:151], v[124:127]
  ds_read_b64_tr_b16 a[90:91], v8 offset:19648
  ds_read_b64_tr_b16 a[94:95], v9 offset:19648
  v_mfma_f32_16x16x32_bf16 v[108:111], v[144:147], a[148:151], v[108:111]
  buffer_load_dwordx4 v[140:143], v29, s[72:75], s97 offen sc1
  v_mfma_f32_16x16x32_bf16 v[64:67], v[160:163], a[160:163], v[64:67]
  v_mfma_f32_16x16x32_bf16 v[80:83], v[164:167], a[160:163], v[80:83]
  v_mfma_f32_16x16x32_bf16 v[84:87], v[164:167], a[164:167], v[84:87]
  global_load_dwordx2 v[16:17], v4, s[32:33]
  v_mfma_f32_16x16x32_bf16 v[68:71], v[160:163], a[164:167], v[68:71]
  v_mfma_f32_16x16x32_bf16 v[72:75], v[160:163], a[176:179], v[72:75]
  v_mfma_f32_16x16x32_bf16 v[88:91], v[164:167], a[176:179], v[88:91]
  v_mfma_f32_16x16x32_bf16 v[92:95], v[164:167], a[180:183], v[92:95]
  s_waitcnt vmcnt(13)
  v_mfma_f32_16x16x32_bf16 v[76:79], v[160:163], a[180:183], v[76:79]
  s_mov_b64 exec, 0xff
  buffer_store_dwordx4 v[28:31], v1, s[72:75], s96 offen offset:3072 sc1
  s_mov_b64 exec, -1
  s_add_u32 s97, s97, 16384
  buffer_load_dwordx4 v[152:155], v28, s[72:75], s97 offen sc1
  v_mfma_f32_16x16x32_bf16 v[96:99], v[176:179], a[160:163], v[96:99]
  v_mfma_f32_16x16x32_bf16 v[112:115], v[180:183], a[160:163], v[112:115]
  v_mfma_f32_16x16x32_bf16 v[116:119], v[180:183], a[164:167], v[116:119]
  buffer_load_dwordx4 v[156:159], v29, s[72:75], s97 offen sc1
  v_mfma_f32_16x16x32_bf16 v[100:103], v[176:179], a[164:167], v[100:103]
  v_mfma_f32_16x16x32_bf16 v[104:107], v[176:179], a[176:179], v[104:107]
  s_lshl_b32 s11, s4, 10
  s_add_u32 s97, s97, 16384
  buffer_load_dwordx4 v[168:171], v28, s[72:75], s97 offen sc1
  v_and_b32 v27, 127, v27
  v_mfma_f32_16x16x32_bf16 v[120:123], v[180:183], a[176:179], v[120:123]
  v_lshlrev_b32 v27, 3, v27
  v_add_u32 v27, 151552, v27
  v_and_b32_e64 v22, 0x30, v1
  v_lshl_add_u32 v22, v25, 6, v22
  v_bfe_u32 v23, v1, 6, 1
  v_lshl_add_u32 v22, v23, 8, v22
  v_bfe_u32 v23, v1, 7, 1
  v_mul_u32_u24 v23, 4224, v23
  v_add3_u32 v22, v22, v23, s11
  v_mfma_f32_16x16x32_bf16 v[124:127], v[180:183], a[180:183], v[124:127]
  ds_read_b64 v[56:57], v27 offset:0
  ds_read_b64 v[58:59], v27 offset:8
  v_mfma_f32_16x16x32_bf16 v[108:111], v[176:179], a[180:183], v[108:111]
  ds_read_b64 v[60:61], v27 offset:256
  ds_read_b64 v[62:63], v27 offset:264
  v_mfma_f32_16x16x32_bf16 v[64:67], v[192:195], a[136:139], v[64:67]
  buffer_load_dwordx4 v[172:175], v29, s[72:75], s97 offen sc1
  v_mfma_f32_16x16x32_bf16 v[80:83], v[196:199], a[136:139], v[80:83]
  v_mfma_f32_16x16x32_bf16 v[84:87], v[196:199], a[140:143], v[84:87]
  s_add_u32 s97, s97, 16384
  buffer_load_dwordx4 v[184:187], v28, s[72:75], s97 offen sc1
  v_mfma_f32_16x16x32_bf16 v[68:71], v[192:195], a[140:143], v[68:71]
  v_mfma_f32_16x16x32_bf16 v[72:75], v[192:195], a[152:155], v[72:75]
  v_mfma_f32_16x16x32_bf16 v[88:91], v[196:199], a[152:155], v[88:91]
  v_mfma_f32_16x16x32_bf16 v[92:95], v[196:199], a[156:159], v[92:95]
  buffer_load_dwordx4 v[188:191], v29, s[72:75], s97 offen sc1
  s_waitcnt vmcnt(18)
  v_mfma_f32_16x16x32_bf16 v[76:79], v[192:195], a[156:159], v[76:79]
  v_mfma_f32_16x16x32_bf16 v[96:99], v[208:211], a[136:139], v[96:99]
  v_mfma_f32_16x16x32_bf16 v[112:115], v[212:215], a[136:139], v[112:115]
  v_mfma_f32_16x16x32_bf16 v[116:119], v[212:215], a[140:143], v[116:119]
  v_lshlrev_b32 v24, 3, v1
  v_mfma_f32_16x16x32_bf16 v[100:103], v[208:211], a[140:143], v[100:103]
  s_mov_b64 exec, 0xff
  buffer_load_dword v24, v24, s[72:75], s98 offen offset:2060 sc1
  s_mov_b64 exec, -1
  v_mfma_f32_16x16x32_bf16 v[104:107], v[208:211], a[152:155], v[104:107]
  v_mfma_f32_16x16x32_bf16 v[120:123], v[212:215], a[152:155], v[120:123]
  v_mfma_f32_16x16x32_bf16 v[124:127], v[212:215], a[156:159], v[124:127]
  s_add_u32 s97, s97, 16384
  buffer_load_dwordx4 v[200:203], v28, s[72:75], s97 offen sc1
  s_waitcnt vmcnt(17)
  v_mfma_f32_16x16x32_bf16 v[108:111], v[208:211], a[156:159], v[108:111]
  v_mfma_f32_16x16x32_bf16 v[64:67], v[224:227], a[168:171], v[64:67]
  v_mfma_f32_16x16x32_bf16 v[80:83], v[228:231], a[168:171], v[80:83]
  v_mfma_f32_16x16x32_bf16 v[84:87], v[228:231], a[172:175], v[84:87]
  buffer_load_dwordx4 v[204:207], v29, s[72:75], s97 offen sc1
  v_mfma_f32_16x16x32_bf16 v[68:71], v[224:227], a[172:175], v[68:71]
  v_mfma_f32_16x16x32_bf16 v[72:75], v[224:227], a[184:187], v[72:75]
  v_mfma_f32_16x16x32_bf16 v[88:91], v[228:231], a[184:187], v[88:91]
Lpad6:
  s_cbranch_execz Lret6
  v_mfma_f32_16x16x32_bf16 v[92:95], v[228:231], a[188:191], v[92:95]
  s_add_u32 s97, s97, 16384
  buffer_load_dwordx4 v[216:219], v28, s[72:75], s97 offen sc1
  s_waitcnt vmcnt(15)
  s_nop 0
  v_mfma_f32_16x16x32_bf16 v[76:79], v[224:227], a[188:191], v[76:79]
  v_mfma_f32_16x16x32_bf16 v[96:99], v[240:243], a[168:171], v[96:99]
  v_mfma_f32_16x16x32_bf16 v[112:115], v[244:247], a[168:171], v[112:115]
  s_nop 0
  v_mfma_f32_16x16x32_bf16 v[116:119], v[244:247], a[172:175], v[116:119]
  buffer_load_dwordx4 v[220:223], v29, s[72:75], s97 offen sc1
  v_mfma_f32_16x16x32_bf16 v[100:103], v[240:243], a[172:175], v[100:103]
  v_mfma_f32_16x16x32_bf16 v[104:107], v[240:243], a[184:187], v[104:107]
  v_mfma_f32_16x16x32_bf16 v[120:123], v[244:247], a[184:187], v[120:123]
  v_mfma_f32_16x16x32_bf16 v[124:127], v[244:247], a[188:191], v[124:127]
  s_add_u32 s97, s97, 16384
  buffer_load_dwordx4 v[232:235], v28, s[72:75], s97 offen sc1
  s_waitcnt vmcnt(14)
  v_mfma_f32_16x16x32_bf16 v[108:111], v[240:243], a[188:191], v[108:111]
  v_mfma_f32_16x16x32_bf16 v[64:67], v[136:139], a[192:195], v[64:67]
  v_mfma_f32_16x16x32_bf16 v[80:83], v[140:143], a[192:195], v[80:83]
  v_mfma_f32_16x16x32_bf16 v[84:87], v[140:143], a[196:199], v[84:87]
  buffer_load_dwordx4 v[236:239], v29, s[72:75], s97 offen sc1
  v_mfma_f32_16x16x32_bf16 v[68:71], v[136:139], a[196:199], v[68:71]
  v_mfma_f32_16x16x32_bf16 v[72:75], v[136:139], a[200:203], v[72:75]
  v_mfma_f32_16x16x32_bf16 v[88:91], v[140:143], a[200:203], v[88:91]
  v_mfma_f32_16x16x32_bf16 v[92:95], v[140:143], a[204:207], v[92:95]
  s_add_u32 s97, s97, 16384
  buffer_load_dwordx4 v[248:251], v28, s[72:75], s97 offen sc1
  s_waitcnt vmcnt(12)
  v_mfma_f32_16x16x32_bf16 v[76:79], v[136:139], a[204:207], v[76:79]
  v_mfma_f32_16x16x32_bf16 v[96:99], v[152:155], a[192:195], v[96:99]
  v_mfma_f32_16x16x32_bf16 v[112:115], v[156:159], a[192:195], v[112:115]
  v_mfma_f32_16x16x32_bf16 v[116:119], v[156:159], a[196:199], v[116:119]
  buffer_load_dwordx4 v[252:255], v29, s[72:75], s97 offen sc1
  v_mfma_f32_16x16x32_bf16 v[100:103], v[152:155], a[196:199], v[100:103]
  v_mfma_f32_16x16x32_bf16 v[104:107], v[152:155], a[200:203], v[104:107]
  v_mfma_f32_16x16x32_bf16 v[120:123], v[156:159], a[200:203], v[120:123]
  v_mfma_f32_16x16x32_bf16 v[124:127], v[156:159], a[204:207], v[124:127]
  s_waitcnt lgkmcnt(15)
  s_add_u32 m0, s28, 34816
  s_waitcnt vmcnt(11)
  v_add_u32_e64 v0, s44, v3
  v_mfma_f32_16x16x32_bf16 v[108:111], v[152:155], a[204:207], v[108:111]
  v_mfma_f32_16x16x32_bf16 v[64:67], v[168:171], a[208:211], v[64:67]
  buffer_load_dwordx4 v0, s[68:71], 0 offen lds
  v_mfma_f32_16x16x32_bf16 v[80:83], v[172:175], a[208:211], v[80:83]
  v_mfma_f32_16x16x32_bf16 v[84:87], v[172:175], a[212:215], v[84:87]
  buffer_load_dwordx4 v0, s[68:71], s86 offen offset:1088 lds
  v_mfma_f32_16x16x32_bf16 v[68:71], v[168:171], a[212:215], v[68:71]
  v_mfma_f32_16x16x32_bf16 v[72:75], v[168:171], a[216:219], v[72:75]
  v_mfma_f32_16x16x32_bf16 v[88:91], v[172:175], a[216:219], v[88:91]
  v_mfma_f32_16x16x32_bf16 v[92:95], v[172:175], a[220:223], v[92:95]
  s_waitcnt vmcnt(10)
  v_cmp_ne_u32 s[0:1], s10, v24
  s_nop 0
  s_and_b32 s0, s0, 0xff
  v_mfma_f32_16x16x32_bf16 v[76:79], v[168:171], a[220:223], v[76:79]
  s_cbranch_scc1 Lfl2_slow
Lfl2_back:
  v_mfma_f32_16x16x32_bf16 v[96:99], v[184:187], a[208:211], v[96:99]
  s_mul_i32 s97, s4, 131072
  s_add_u32 s97, s97, s101
  s_add_u32 s97, s97, 1572864
  buffer_load_dwordx4 v[128:131], v28, s[72:75], s97 offen sc1
  buffer_load_dwordx4 v[132:135], v29, s[72:75], s97 offen sc1
  v_mfma_f32_16x16x32_bf16 v[112:115], v[188:191], a[208:211], v[112:115]
  v_mfma_f32_16x16x32_bf16 v[116:119], v[188:191], a[212:215], v[116:119]
  v_mfma_f32_16x16x32_bf16 v[100:103], v[184:187], a[212:215], v[100:103]
  v_mfma_f32_16x16x32_bf16 v[104:107], v[184:187], a[216:219], v[104:107]
  s_add_u32 s97, s97, 16384
  buffer_load_dwordx4 v[144:147], v28, s[72:75], s97 offen sc1
  v_lshlrev_b32 v10, 16, v16
  v_mfma_f32_16x16x32_bf16 v[120:123], v[188:191], a[216:219], v[120:123]
  v_and_b32 v11, s16, v16
  v_mfma_f32_16x16x32_bf16 v[124:127], v[188:191], a[220:223], v[124:127]
  s_waitcnt vmcnt(11)
  v_lshlrev_b32 v12, 16, v17
  v_and_b32_e64 v13, s16, v17
  v_mfma_f32_16x16x32_bf16 v[108:111], v[184:187], a[220:223], v[108:111]
  v_mfma_f32_16x16x32_bf16 v[64:67], v[200:203], a[224:227], v[64:67]
  buffer_load_dwordx4 v[148:151], v29, s[72:75], s97 offen sc1
  v_lshlrev_b32 v32, 16, v48
  v_mfma_f32_16x16x32_bf16 v[80:83], v[204:207], a[224:227], v[80:83]
  s_waitcnt lgkmcnt(3)
  v_fma_f32 v5, v32, v56, v57
  v_mfma_f32_16x16x32_bf16 v[84:87], v[204:207], a[228:231], v[84:87]
  v_fmac_f32_e64 v32, v5, v10
  v_mfma_f32_16x16x32_bf16 v[68:71], v[200:203], a[228:231], v[68:71]
  v_mfma_f32_16x16x32_bf16 v[72:75], v[200:203], a[232:235], v[72:75]
  s_add_u32 s97, s97, 16384
  buffer_load_dwordx4 v[160:163], v28, s[72:75], s97 offen sc1
  v_and_b32_e64 v33, s16, v48
  v_mfma_f32_16x16x32_bf16 v[88:91], v[204:207], a[232:235], v[88:91]
  v_fma_f32 v5, v33, v56, v57
  v_mfma_f32_16x16x32_bf16 v[92:95], v[204:207], a[236:239], v[92:95]
  s_waitcnt vmcnt(11)
  v_fmac_f32 v33, v5, v11
  v_lshlrev_b32_e64 v34, 16, v49
  v_mfma_f32_16x16x32_bf16 v[76:79], v[200:203], a[236:239], v[76:79]
  v_mfma_f32_16x16x32_bf16 v[96:99], v[216:219], a[224:227], v[96:99]
  buffer_load_dwordx4 v[164:167], v29, s[72:75], s97 offen sc1
  v_fma_f32 v5, v34, v56, v57
  v_mfma_f32_16x16x32_bf16 v[112:115], v[220:223], a[224:227], v[112:115]
  v_mfma_f32_16x16x32_bf16 v[116:119], v[220:223], a[228:231], v[116:119]
  v_fmac_f32_e64 v34, v5, v12
  v_and_b32_e64 v35, s16, v49
  v_mfma_f32_16x16x32_bf16 v[100:103], v[216:219], a[228:231], v[100:103]
  v_mfma_f32_16x16x32_bf16 v[104:107], v[216:219], a[232:235], v[104:107]
  s_add_u32 s97, s97, 16384
  buffer_load_dwordx4 v[176:179], v28, s[72:75], s97 offen sc1
  v_fma_f32 v5, v35, v56, v57
  v_mfma_f32_16x16x32_bf16 v[120:123], v[220:223], a[232:235], v[120:123]
  v_fmac_f32_e64 v35, v5, v13
  v_mfma_f32_16x16x32_bf16 v[124:127], v[220:223], a[236:239], v[124:127]
  s_waitcnt vmcnt(11)
  v_lshlrev_b32 v36, 16, v50
  v_mfma_f32_16x16x32_bf16 v[108:111], v[216:219], a[236:239], v[108:111]
  v_mfma_f32_16x16x32_bf16 v[64:67], v[232:235], a[240:243], v[64:67]
  buffer_load_dwordx4 v[180:183], v29, s[72:75], s97 offen sc1
  s_waitcnt lgkmcnt(2)
  v_fma_f32 v5, v36, v58, v59
  v_mfma_f32_16x16x32_bf16 v[80:83], v[236:239], a[240:243], v[80:83]
  v_fmac_f32 v36, v5, v10
  v_mfma_f32_16x16x32_bf16 v[84:87], v[236:239], a[244:247], v[84:87]
  v_and_b32_e64 v37, s16, v50
  v_fma_f32 v5, v37, v58, v59
  v_mfma_f32_16x16x32_bf16 v[68:71], v[232:235], a[244:247], v[68:71]
  v_mfma_f32_16x16x32_bf16 v[72:75], v[232:235], a[248:251], v[72:75]
  v_fmac_f32_e64 v37, v5, v11
  v_lshlrev_b32_e64 v24, 3, v1
  v_mfma_f32_16x16x32_bf16 v[88:91], v[236:239], a[248:251], v[88:91]
  s_mov_b64 exec, 0xff
  s_mov_b32 exec_lo, s99
  buffer_load_dword v24, v24, s[72:75], s98 offen offset:3084 sc1
  s_mov_b64 exec, -1
  v_mfma_f32_16x16x32_bf16 v[92:95], v[236:239], a[252:255], v[92:95]
  s_waitcnt vmcnt(9)
  ds_read_b64_tr_b16 a[96:97], v8 offset:34816
  ds_read_b64_tr_b16 a[100:101], v9 offset:34816
  v_mfma_f32_16x16x32_bf16 v[76:79], v[232:235], a[252:255], v[76:79]
  s_nop 0
  s_add_u32 s97, s97, 16384
  buffer_load_dwordx4 v[192:195], v28, s[72:75], s97 offen sc1
  v_lshlrev_b32_e64 v38, 16, v51
  v_fma_f32 v5, v38, v58, v59
  v_mfma_f32_16x16x32_bf16 v[96:99], v[248:251], a[240:243], v[96:99]
  ds_read_b64_tr_b16 a[104:105], v8 offset:34880
  ds_read_b64_tr_b16 a[108:109], v9 offset:34880
  v_mfma_f32_16x16x32_bf16 v[112:115], v[252:255], a[240:243], v[112:115]
  v_fmac_f32_e64 v38, v5, v12
  v_and_b32_e64 v39, s16, v51
  v_mfma_f32_16x16x32_bf16 v[116:119], v[252:255], a[244:247], v[116:119]
  buffer_load_dwordx4 v[196:199], v29, s[72:75], s97 offen sc1
  v_fma_f32 v5, v39, v58, v59
  v_mfma_f32_16x16x32_bf16 v[100:103], v[248:251], a[244:247], v[100:103]
  v_mfma_f32_16x16x32_bf16 v[104:107], v[248:251], a[248:251], v[104:107]
  v_fmac_f32_e64 v39, v5, v13
  v_lshlrev_b32_e64 v40, 16, v52
  v_mfma_f32_16x16x32_bf16 v[120:123], v[252:255], a[248:251], v[120:123]
  v_mfma_f32_16x16x32_bf16 v[124:127], v[252:255], a[252:255], v[124:127]
  s_add_u32 s97, s97, 16384
  buffer_load_dwordx4 v[208:211], v28, s[72:75], s97 offen sc1
  s_waitcnt vmcnt(10) lgkmcnt(5)
  v_fma_f32 v5, v40, v60, v61
  v_mfma_f32_16x16x32_bf16 v[108:111], v[248:251], a[252:255], v[108:111]
  v_fmac_f32 v40, v5, v10
  v_mfma_f32_16x16x32_bf16 v[64:67], v[128:131], a[32:35], v[64:67]
  v_and_b32_e64 v41, s16, v52
  v_mfma_f32_16x16x32_bf16 v[80:83], v[132:135], a[32:35], v[80:83]
  v_mfma_f32_16x16x32_bf16 v[84:87], v[132:135], a[36:39], v[84:87]
  buffer_load_dwordx4 v[212:215], v29, s[72:75], s97 offen sc1
  v_fma_f32 v5, v41, v60, v61
  v_mfma_f32_16x16x32_bf16 v[68:71], v[128:131], a[36:39], v[68:71]
  v_fmac_f32_e64 v41, v5, v11
  v_mfma_f32_16x16x32_bf16 v[72:75], v[128:131], a[40:43], v[72:75]
  v_lshlrev_b32_e64 v42, 16, v53
  v_fma_f32 v5, v42, v60, v61
  v_mfma_f32_16x16x32_bf16 v[88:91], v[132:135], a[40:43], v[88:91]
  v_mfma_f32_16x16x32_bf16 v[92:95], v[132:135], a[44:47], v[92:95]
  buffer_load_dwordx4 v0, s[68:71], s84 offen offset:2176 lds
  s_waitcnt vmcnt(10)
  v_fmac_f32 v42, v5, v12
  v_mfma_f32_16x16x32_bf16 v[76:79], v[128:131], a[44:47], v[76:79]
  v_mfma_f32_16x16x32_bf16 v[96:99], v[144:147], a[32:35], v[96:99]
  v_and_b32_e64 v43, s16, v53
  v_fma_f32 v5, v43, v60, v61
  v_mfma_f32_16x16x32_bf16 v[112:115], v[148:151], a[32:35], v[112:115]
  v_mfma_f32_16x16x32_bf16 v[116:119], v[148:151], a[36:39], v[116:119]
  buffer_load_dwordx4 v0, s[68:71], s87 offen offset:3264 lds
  v_fmac_f32_e64 v43, v5, v13
  v_mfma_f32_16x16x32_bf16 v[100:103], v[144:147], a[36:39], v[100:103]
  v_lshlrev_b32 v44, 16, v54
  v_mfma_f32_16x16x32_bf16 v[104:107], v[144:147], a[40:43], v[104:107]
  s_waitcnt lgkmcnt(4)
  v_fma_f32 v5, v44, v62, v63
  v_mfma_f32_16x16x32_bf16 v[120:123], v[148:151], a[40:43], v[120:123]
  v_mfma_f32_16x16x32_bf16 v[124:127], v[148:151], a[44:47], v[124:127]
  s_add_u32 s97, s97, 16384
  buffer_load_dwordx4 v[224:227], v28, s[72:75], s97 offen sc1
  buffer_load_dwordx4 v[228:231], v29, s[72:75], s97 offen sc1
  v_mfma_f32_16x16x32_bf16 v[108:111], v[144:147], a[44:47], v[108:111]
  s_waitcnt vmcnt(11)
  v_fmac_f32 v44, v5, v10
  v_and_b32_e64 v45, s16, v54
  v_mfma_f32_16x16x32_bf16 v[64:67], v[160:163], a[48:51], v[64:67]
  v_fma_f32 v5, v45, v62, v63
  v_fmac_f32 v45, v5, v11
  v_mfma_f32_16x16x32_bf16 v[80:83], v[164:167], a[48:51], v[80:83]
  v_mfma_f32_16x16x32_bf16 v[84:87], v[164:167], a[52:55], v[84:87]
  v_lshlrev_b32 v46, 16, v55
  v_mfma_f32_16x16x32_bf16 v[68:71], v[160:163], a[52:55], v[68:71]
  v_mfma_f32_16x16x32_bf16 v[72:75], v[160:163], a[56:59], v[72:75]
  v_fma_f32 v5, v46, v62, v63
  v_fmac_f32_e64 v46, v5, v12
  v_mfma_f32_16x16x32_bf16 v[88:91], v[164:167], a[56:59], v[88:91]
  v_mfma_f32_16x16x32_bf16 v[92:95], v[164:167], a[60:63], v[92:95]
  s_add_u32 s97, s97, 16384
  buffer_load_dwordx4 v[240:243], v28, s[72:75], s97 offen sc1
  buffer_load_dwordx4 v[244:247], v29, s[72:75], s97 offen sc1
  v_mfma_f32_16x16x32_bf16 v[76:79], v[160:163], a[60:63], v[76:79]
  s_waitcnt vmcnt(11)
  v_and_b32 v47, s16, v55
  v_fma_f32 v5, v47, v62, v63
  v_mfma_f32_16x16x32_bf16 v[96:99], v[176:179], a[48:51], v[96:99]
  v_fmac_f32_e64 v47, v5, v13
  v_mfma_f32_16x16x32_bf16 v[112:115], v[180:183], a[48:51], v[112:115]
  v_mfma_f32_16x16x32_bf16 v[116:119], v[180:183], a[52:55], v[116:119]
  v_mfma_f32_16x16x32_bf16 v[100:103], v[176:179], a[52:55], v[100:103]
  v_mfma_f32_16x16x32_bf16 v[104:107], v[176:179], a[56:59], v[104:107]
  s_waitcnt vmcnt(10)
  v_cmp_ne_u32 s[0:1], s10, v24
  s_nop 0
  s_and_b32 s0, s0, s99
  v_mfma_f32_16x16x32_bf16 v[120:123], v[180:183], a[56:59], v[120:123]
  s_cbranch_scc1 Lfl3_slow
Lfl3_back:
  v_mfma_f32_16x16x32_bf16 v[124:127], v[180:183], a[60:63], v[124:127]
  s_mul_i32 s97, s4, 98304
  s_add_u32 s97, s97, s101
  s_add_u32 s22, s97, 2097152
  s_add_u32 s23, s97, 2113536
  s_add_u32 s24, s97, 2129920
  s_nop 0
  s_add_u32 s25, s97, 2146304
  s_add_u32 s26, s97, 2162688
  s_add_u32 s27, s97, 2179072
  s_cmp_eq_u32 s4, 3
  s_cselect_b32 s26, 1073741824, s26
  s_cselect_b32 s27, 1073741824, s27
  buffer_load_dwordx4 v[136:139], v28, s[72:75], s22 offen sc1
  buffer_load_dwordx4 v[140:143], v29, s[72:75], s22 offen sc1
  v_mfma_f32_16x16x32_bf16 v[108:111], v[176:179], a[60:63], v[108:111]
  s_waitcnt vmcnt(10)
  v_mfma_f32_16x16x32_bf16 v[64:67], v[192:195], a[0:3], v[64:67]
  v_mfma_f32_16x16x32_bf16 v[80:83], v[196:199], a[0:3], v[80:83]
  v_mfma_f32_16x16x32_bf16 v[84:87], v[196:199], a[4:7], v[84:87]
  buffer_load_dwordx4 v[168:171], v28, s[72:75], s24 offen sc1
  v_mfma_f32_16x16x32_bf16 v[68:71], v[192:195], a[4:7], v[68:71]
  v_mfma_f32_16x16x32_bf16 v[72:75], v[192:195], a[8:11], v[72:75]
  v_mfma_f32_16x16x32_bf16 v[88:91], v[196:199], a[8:11], v[88:91]
  v_mfma_f32_16x16x32_bf16 v[92:95], v[196:199], a[12:15], v[92:95]
  buffer_load_dwordx4 v[172:175], v29, s[72:75], s24 offen sc1
  s_waitcnt vmcnt(10)
  v_mfma_f32_16x16x32_bf16 v[76:79], v[192:195], a[12:15], v[76:79]
  v_mfma_f32_16x16x32_bf16 v[96:99], v[208:211], a[0:3], v[96:99]
  v_mfma_f32_16x16x32_bf16 v[112:115], v[212:215], a[0:3], v[112:115]
  v_mfma_f32_16x16x32_bf16 v[116:119], v[212:215], a[4:7], v[116:119]
  buffer_load_dwordx4 v[200:203], v28, s[72:75], s26 offen sc1
  v_mfma_f32_16x16x32_bf16 v[100:103], v[208:211], a[4:7], v[100:103]
  v_mfma_f32_16x16x32_bf16 v[104:107], v[208:211], a[8:11], v[104:107]
  s_waitcnt vmcnt(9)
  ds_read_b64_tr_b16 a[98:99], v8 offset:36992
  ds_read_b64_tr_b16 a[102:103], v9 offset:36992
  v_mfma_f32_16x16x32_bf16 v[120:123], v[212:215], a[8:11], v[120:123]
  buffer_load_dwordx4 v[204:207], v29, s[72:75], s26 offen sc1
  v_mfma_f32_16x16x32_bf16 v[124:127], v[212:215], a[12:15], v[124:127]
  ds_read_b64_tr_b16 a[106:107], v8 offset:37056
  ds_read_b64_tr_b16 a[110:111], v9 offset:37056
  v_mfma_f32_16x16x32_bf16 v[108:111], v[208:211], a[12:15], v[108:111]
  s_waitcnt vmcnt(8)
  v_mfma_f32_16x16x32_bf16 v[64:67], v[224:227], a[16:19], v[64:67]
  buffer_load_dwordx4 v[152:155], v28, s[72:75], s23 offen sc1
  v_mfma_f32_16x16x32_bf16 v[80:83], v[228:231], a[16:19], v[80:83]
  v_mfma_f32_16x16x32_bf16 v[84:87], v[228:231], a[20:23], v[84:87]
  v_mfma_f32_16x16x32_bf16 v[68:71], v[224:227], a[20:23], v[68:71]
  v_mfma_f32_16x16x32_bf16 v[72:75], v[224:227], a[24:27], v[72:75]
  buffer_load_dwordx4 v[156:159], v29, s[72:75], s23 offen sc1
  v_mfma_f32_16x16x32_bf16 v[88:91], v[228:231], a[24:27], v[88:91]
  v_mfma_f32_16x16x32_bf16 v[92:95], v[228:231], a[28:31], v[92:95]
  s_waitcnt vmcnt(8)
  v_mfma_f32_16x16x32_bf16 v[76:79], v[224:227], a[28:31], v[76:79]
  v_mfma_f32_16x16x32_bf16 v[96:99], v[240:243], a[16:19], v[96:99]
  buffer_load_dwordx4 v[184:187], v28, s[72:75], s25 offen sc1
  v_mfma_f32_16x16x32_bf16 v[112:115], v[244:247], a[16:19], v[112:115]
  v_mfma_f32_16x16x32_bf16 v[116:119], v[244:247], a[20:23], v[116:119]
  v_mfma_f32_16x16x32_bf16 v[100:103], v[240:243], a[20:23], v[100:103]
  v_mfma_f32_16x16x32_bf16 v[104:107], v[240:243], a[24:27], v[104:107]
  buffer_load_dwordx4 v[188:191], v29, s[72:75], s25 offen sc1
  v_mfma_f32_16x16x32_bf16 v[120:123], v[244:247], a[24:27], v[120:123]
  v_mfma_f32_16x16x32_bf16 v[124:127], v[244:247], a[28:31], v[124:127]
  s_waitcnt vmcnt(8)
  v_mfma_f32_16x16x32_bf16 v[108:111], v[240:243], a[28:31], v[108:111]
  v_mfma_f32_16x16x32_bf16 v[64:67], v[136:139], a[64:67], v[64:67]
  buffer_load_dwordx4 v[216:219], v28, s[72:75], s27 offen sc1
  v_mfma_f32_16x16x32_bf16 v[80:83], v[140:143], a[64:67], v[80:83]
  v_mfma_f32_16x16x32_bf16 v[84:87], v[140:143], a[68:71], v[84:87]
  v_mfma_f32_16x16x32_bf16 v[68:71], v[136:139], a[68:71], v[68:71]
  v_mfma_f32_16x16x32_bf16 v[72:75], v[136:139], a[72:75], v[72:75]
  buffer_load_dwordx4 v[220:223], v29, s[72:75], s27 offen sc1
  v_mfma_f32_16x16x32_bf16 v[88:91], v[140:143], a[72:75], v[88:91]
  v_mfma_f32_16x16x32_bf16 v[92:95], v[140:143], a[76:79], v[92:95]
  s_waitcnt vmcnt(8)
  v_mfma_f32_16x16x32_bf16 v[76:79], v[136:139], a[76:79], v[76:79]
  v_mfma_f32_16x16x32_bf16 v[64:67], v[168:171], a[80:83], v[64:67]
  v_mfma_f32_16x16x32_bf16 v[80:83], v[172:175], a[80:83], v[80:83]
  v_mfma_f32_16x16x32_bf16 v[84:87], v[172:175], a[84:87], v[84:87]
  v_mfma_f32_16x16x32_bf16 v[68:71], v[168:171], a[84:87], v[68:71]
  v_mfma_f32_16x16x32_bf16 v[72:75], v[168:171], a[88:91], v[72:75]
  v_mfma_f32_16x16x32_bf16 v[88:91], v[172:175], a[88:91], v[88:91]
  v_mfma_f32_16x16x32_bf16 v[92:95], v[172:175], a[92:95], v[92:95]
  s_waitcnt vmcnt(6)
  v_mfma_f32_16x16x32_bf16 v[76:79], v[168:171], a[92:95], v[76:79]
  s_waitcnt lgkmcnt(3)
  v_mfma_f32_16x16x32_bf16 v[64:67], v[200:203], a[96:99], v[64:67]
  v_mfma_f32_16x16x32_bf16 v[80:83], v[204:207], a[96:99], v[80:83]
  s_waitcnt lgkmcnt(2)
  v_mfma_f32_16x16x32_bf16 v[84:87], v[204:207], a[100:103], v[84:87]
  v_mfma_f32_16x16x32_bf16 v[68:71], v[200:203], a[100:103], v[68:71]
  s_waitcnt lgkmcnt(1)
  v_mfma_f32_16x16x32_bf16 v[72:75], v[200:203], a[104:107], v[72:75]
  v_mfma_f32_16x16x32_bf16 v[88:91], v[204:207], a[104:107], v[88:91]
  s_waitcnt lgkmcnt(0)
  v_mfma_f32_16x16x32_bf16 v[92:95], v[204:207], a[108:111], v[92:95]
  s_waitcnt vmcnt(4)
  v_mfma_f32_16x16x32_bf16 v[76:79], v[200:203], a[108:111], v[76:79]
  v_mfma_f32_16x16x32_bf16 v[96:99], v[152:155], a[64:67], v[96:99]
  s_mul_i32 m0, s4, 16896
  v_mfma_f32_16x16x32_bf16 v[112:115], v[156:159], a[64:67], v[112:115]
  v_mfma_f32_16x16x32_bf16 v[116:119], v[156:159], a[68:71], v[116:119]
  ds_write_addtid_b32 v64 offset:0
  ds_write_addtid_b32 v65 offset:512
  v_mfma_f32_16x16x32_bf16 v[100:103], v[152:155], a[68:71], v[100:103]
  ds_write_addtid_b32 v66 offset:1024
  ds_write_addtid_b32 v67 offset:1536
  ds_write_addtid_b32 v68 offset:256
  v_mfma_f32_16x16x32_bf16 v[104:107], v[152:155], a[72:75], v[104:107]
  ds_write_addtid_b32 v69 offset:768
  ds_write_addtid_b32 v70 offset:1280
  v_mfma_f32_16x16x32_bf16 v[120:123], v[156:159], a[72:75], v[120:123]
  ds_write_addtid_b32 v71 offset:1792
  ds_write_addtid_b32 v72 offset:4224
  ds_write_addtid_b32 v73 offset:4736
  v_mfma_f32_16x16x32_bf16 v[124:127], v[156:159], a[76:79], v[124:127]
  ds_write_addtid_b32 v74 offset:5248
  ds_write_addtid_b32 v75 offset:5760
  v_mfma_f32_16x16x32_bf16 v[108:111], v[152:155], a[76:79], v[108:111]
  ds_write_addtid_b32 v76 offset:4480
  ds_write_addtid_b32 v77 offset:4992
  s_waitcnt vmcnt(2)
  s_nop 0
  v_mfma_f32_16x16x32_bf16 v[96:99], v[184:187], a[80:83], v[96:99]
  ds_write_addtid_b32 v78 offset:5504
  ds_write_addtid_b32 v79 offset:6016
  v_mfma_f32_16x16x32_bf16 v[112:115], v[188:191], a[80:83], v[112:115]
  ds_write_addtid_b32 v80 offset:2048
  ds_write_addtid_b32 v81 offset:2560
  ds_write_addtid_b32 v82 offset:3072
  v_mfma_f32_16x16x32_bf16 v[116:119], v[188:191], a[84:87], v[116:119]
  ds_write_addtid_b32 v83 offset:3584
  ds_write_addtid_b32 v84 offset:2304
  v_mfma_f32_16x16x32_bf16 v[100:103], v[184:187], a[84:87], v[100:103]
  ds_write_addtid_b32 v85 offset:2816
  ds_write_addtid_b32 v86 offset:3328
  v_mfma_f32_16x16x32_bf16 v[104:107], v[184:187], a[88:91], v[104:107]
  ds_write_addtid_b32 v87 offset:3840
  ds_write_addtid_b32 v88 offset:6272
  v_mfma_f32_16x16x32_bf16 v[120:123], v[188:191], a[88:91], v[120:123]
  ds_write_addtid_b32 v89 offset:6784
  ds_write_addtid_b32 v90 offset:7296
  ds_write_addtid_b32 v91 offset:7808
  v_mfma_f32_16x16x32_bf16 v[124:127], v[188:191], a[92:95], v[124:127]
  ds_write_addtid_b32 v92 offset:6528
  ds_write_addtid_b32 v93 offset:7040
  v_mfma_f32_16x16x32_bf16 v[108:111], v[184:187], a[92:95], v[108:111]
  ds_write_addtid_b32 v94 offset:7552
  ds_write_addtid_b32 v95 offset:8064
  s_waitcnt vmcnt(0)
  v_mfma_f32_16x16x32_bf16 v[96:99], v[216:219], a[96:99], v[96:99]
  s_nop 0
  v_mfma_f32_16x16x32_bf16 v[112:115], v[220:223], a[96:99], v[112:115]
  v_mfma_f32_16x16x32_bf16 v[116:119], v[220:223], a[100:103], v[116:119]
  s_waitcnt lgkmcnt(0)
  s_barrier
  ds_read_b128 v[232:235], v22 offset:0
  ds_read_b128 v[236:239], v22 offset:16896
  v_mfma_f32_16x16x32_bf16 v[100:103], v[216:219], a[100:103], v[100:103]
  ds_read_b128 v[248:251], v22 offset:33792
  ds_read_b128 v[252:255], v22 offset:50688
  ds_read_b128 v[128:131], v22 offset:512
  ds_read_b128 v[132:135], v22 offset:17408
  ds_read_b128 v[144:147], v22 offset:34304
  ds_read_b128 v[148:151], v22 offset:51200
  v_mfma_f32_16x16x32_bf16 v[104:107], v[216:219], a[104:107], v[104:107]
  v_mfma_f32_16x16x32_bf16 v[120:123], v[220:223], a[104:107], v[120:123]
  v_mfma_f32_16x16x32_bf16 v[124:127], v[220:223], a[108:111], v[124:127]
  s_waitcnt lgkmcnt(4)
  v_add_f32 v232, v232, v32
  v_add_f32 v233, v233, v33
  v_mfma_f32_16x16x32_bf16 v[108:111], v[216:219], a[108:111], v[108:111]
  v_add_f32 v234, v234, v34
  v_add_f32 v235, v235, v35
  v_add_f32 v248, v248, v252
  v_add_f32 v249, v249, v253
  v_add_f32 v250, v250, v254
  v_add_f32 v251, v251, v255
  v_add_f32 v232, v232, v236
  v_add_f32 v233, v233, v237
  v_add_f32 v234, v234, v238
  v_add_f32 v235, v235, v239
  v_add_f32 v232, v232, v248
  v_add_f32 v233, v233, v249
  v_add_f32 v234, v234, v250
  v_add_f32_e64 v235, v235, v251
  buffer_store_dwordx4 v[232:235], v14, s[76:79], 0 offen offset:0 sc1
  ds_write_addtid_b32 v96 offset:8448
  ds_write_addtid_b32 v97 offset:8960
  ds_write_addtid_b32 v98 offset:9472
  ds_write_addtid_b32 v99 offset:9984
  ds_write_addtid_b32 v100 offset:8704
  ds_write_addtid_b32 v101 offset:9216
  ds_write_addtid_b32 v102 offset:9728
  ds_write_addtid_b32 v103 offset:10240
  ds_write_addtid_b32 v104 offset:12672
  ds_write_addtid_b32 v105 offset:13184
  ds_write_addtid_b32 v106 offset:13696
  ds_write_addtid_b32 v107 offset:14208
  ds_write_addtid_b32 v108 offset:12928
  ds_write_addtid_b32 v109 offset:13440
  ds_write_addtid_b32 v110 offset:13952
  ds_write_addtid_b32 v111 offset:14464
  ds_write_addtid_b32 v112 offset:10496
  ds_write_addtid_b32 v113 offset:11008
  ds_write_addtid_b32 v114 offset:11520
  ds_write_addtid_b32 v115 offset:12032
  ds_write_addtid_b32 v116 offset:10752
  ds_write_addtid_b32 v117 offset:11264
  ds_write_addtid_b32 v118 offset:11776
  ds_write_addtid_b32 v119 offset:12288
  ds_write_addtid_b32 v120 offset:14720
  ds_write_addtid_b32 v121 offset:15232
  ds_write_addtid_b32 v122 offset:15744
  ds_write_addtid_b32 v123 offset:16256
  ds_write_addtid_b32 v124 offset:14976
  ds_write_addtid_b32 v125 offset:15488
  ds_write_addtid_b32 v126 offset:16000
  ds_write_addtid_b32 v127 offset:16512
  s_waitcnt lgkmcnt(15)
  v_pk_add_f32 v[128:129], v[128:129], v[36:37]
  s_nop 0
  v_pk_add_f32 v[130:131], v[130:131], v[38:39]
  v_pk_add_f32 v[144:145], v[144:145], v[148:149]
  v_pk_add_f32 v[146:147], v[146:147], v[150:151]
  v_pk_add_f32 v[128:129], v[128:129], v[132:133]
  v_pk_add_f32 v[130:131], v[130:131], v[134:135]
  v_pk_add_f32 v[128:129], v[128:129], v[144:145]
  v_pk_add_f32 v[130:131], v[130:131], v[146:147]
  buffer_store_dwordx4 v[128:131], v14, s[76:79], 0 offen offset:2048 sc1
  s_cmp_eq_u32 s2, 255
  s_cselect_b32 s3, 0, 1073741824
  s_mov_b64 exec, 1
  buffer_store_dword v31, off, s[72:75], s3 sc1
  s_mov_b64 exec, -1
  s_waitcnt lgkmcnt(0)
  s_barrier
  ds_read_b128 v[160:163], v22 offset:8448
  ds_read_b128 v[164:167], v22 offset:25344
  ds_read_b128 v[176:179], v22 offset:42240
  s_nop 0
  ds_read_b128 v[180:183], v22 offset:59136
  ds_read_b128 v[192:195], v22 offset:8960
  ds_read_b128 v[196:199], v22 offset:25856
  ds_read_b128 v[208:211], v22 offset:42752
  ds_read_b128 v[212:215], v22 offset:59648
  s_waitcnt lgkmcnt(4)
  v_pk_add_f32 v[160:161], v[160:161], v[40:41]
  v_pk_add_f32 v[162:163], v[162:163], v[42:43]
  v_pk_add_f32 v[176:177], v[176:177], v[180:181]
  v_pk_add_f32 v[178:179], v[178:179], v[182:183]
  v_pk_add_f32 v[160:161], v[160:161], v[164:165]
  v_pk_add_f32 v[162:163], v[162:163], v[166:167]
  v_pk_add_f32 v[160:161], v[160:161], v[176:177]
  v_pk_add_f32 v[162:163], v[162:163], v[178:179]
  buffer_store_dwordx4 v[160:163], v14, s[76:79], s20 offen offset:0 sc1
  s_waitcnt lgkmcnt(0)
  v_pk_add_f32 v[192:193], v[192:193], v[44:45]
  v_pk_add_f32 v[194:195], v[194:195], v[46:47]
  v_pk_add_f32 v[208:209], v[208:209], v[212:213]
  v_pk_add_f32 v[210:211], v[210:211], v[214:215]
  v_pk_add_f32 v[192:193], v[192:193], v[196:197]
  v_pk_add_f32 v[194:195], v[194:195], v[198:199]
  v_pk_add_f32 v[192:193], v[192:193], v[208:209]
  v_pk_add_f32 v[194:195], v[194:195], v[210:211]
  buffer_store_dwordx4 v[192:195], v14, s[76:79], s20 offen offset:2048 sc1
Lend:
  s_endpgm
Le_slow:
  s_nop 7
  v_accvgpr_read_b32 v24, a46
  v_accvgpr_read_b32 v28, a47
  buffer_load_dwordx4 v[24:27], v24, s[72:75], s15 offen sc1
  buffer_load_dwordx4 v[28:31], v28, s[72:75], s15 offen sc1
  s_waitcnt vmcnt(0)
  s_add_u32 s100, s100, 1
  s_cmp_gt_u32 s100, 200000
  s_cbranch_scc1 Le_back
  v_xor_b32 v24, s10, v24
  v_xor_b32 v28, s10, v28
  v_xor_b32 v25, s10, v25
  v_xor_b32 v29, s10, v29
  v_or_b32 v24, v24, v25
  v_or_b32_e64 v28, v28, v29
  v_cmp_ne_u32 s[0:1], 0, v24
  v_cmp_ne_u32 vcc, 0, v28
  s_and_b64 s[0:1], s[0:1], s[20:21]
  s_and_b64 vcc, vcc, s[18:19]
  s_or_b64 s[0:1], s[0:1], vcc
  s_cbranch_scc1 Le_slow
  s_nop 3
  s_branch Le_back
Lfl0_slow:
  s_nop 7
  v_lshlrev_b32 v24, 3, v1
  s_mov_b64 exec, 0xff
  buffer_load_dword v24, v24, s[72:75], s98 offen offset:12 sc1
  s_mov_b64 exec, -1
  s_waitcnt vmcnt(0)
  s_add_u32 s100, s100, 1
  s_cmp_gt_u32 s100, 200000
  s_cbranch_scc1 Lfl0_back
  v_cmp_ne_u32 s[0:1], s10, v24
  s_nop 0
  s_and_b32 s0, s0, 0xff
  s_cbranch_scc1 Lfl0_slow
  s_nop 3
  s_branch Lfl0_back
Lfl1_slow:
  s_nop 7
  v_lshlrev_b32_e64 v24, 3, v1
  s_mov_b64 exec, 0xff
  buffer_load_dword v24, v24, s[72:75], s98 offen offset:1036 sc1
  s_mov_b64 exec, -1
  s_waitcnt vmcnt(0)
  s_add_u32 s100, s100, 1
  s_cmp_gt_u32 s100, 200000
  s_cbranch_scc1 Lfl1_back
  v_cmp_ne_u32 s[0:1], s10, v24
  s_nop 0
  s_and_b32 s0, s0, 0xff
  s_cbranch_scc1 Lfl1_slow
  s_nop 3
  s_branch Lfl1_back
Lfl2_slow:
  s_nop 7
  v_lshlrev_b32_e64 v24, 3, v1
  s_mov_b64 exec, 0xff
  buffer_load_dword v24, v24, s[72:75], s98 offen offset:2060 sc1
  s_mov_b64 exec, -1
  s_waitcnt vmcnt(0)
  s_add_u32 s100, s100, 1
  s_cmp_gt_u32 s100, 200000
  s_cbranch_scc1 Lfl2_back
  v_cmp_ne_u32 s[0:1], s10, v24
  s_nop 0
  s_and_b32 s0, s0, 0xff
  s_cbranch_scc1 Lfl2_slow
  s_nop 3
  s_branch Lfl2_back
Lfl3_slow:
  s_nop 7
  v_lshlrev_b32_e64 v24, 3, v1
  s_mov_b64 exec, 0xff
  s_mov_b32 exec_lo, s99
  buffer_load_dword v24, v24, s[72:75], s98 offen offset:3084 sc1
  s_mov_b64 exec, -1
  s_waitcnt vmcnt(0)
  s_add_u32 s100, s100, 1
  s_cmp_gt_u32 s100, 200000
  s_cbranch_scc1 Lfl3_back
  v_cmp_ne_u32 s[0:1], s10, v24
  s_nop 0
  s_and_b32 s0, s0, s99
  s_cbranch_scc1 Lfl3_slow
  s_nop 3
  s_branch Lfl3_back
Lcode_end:

.section .rodata,"a"
.p2align 6
.amdhsa_kernel parallel_sum__ssm_conv_s5__geglu_ffn__prompt_kernel
  .amdhsa_next_free_vgpr 512
  .amdhsa_next_free_sgpr 102
  .amdhsa_accum_offset 256
  .amdhsa_group_segment_fixed_size 0
  .amdhsa_kernarg_size 128
  .amdhsa_user_sgpr_count 2
  .amdhsa_user_sgpr_kernarg_segment_ptr 1
  .amdhsa_system_sgpr_workgroup_id_x 1
.end_amdhsa_kernel
```
